```python
import torch

def _softmax(x, axis=-1):
    return torch.softmax(x, dim=axis)
def _gelu(x):
    return torch.nn.functional.gelu(x, approximate="tanh")
def _silu(x):
    return torch.nn.functional.silu(x)
def _sigmoid(x):
    return torch.sigmoid(x)
def _layernorm(x, axis=-1, eps=1e-5):
    m = x.mean(dim=axis, keepdim=True)
    v = x.var(dim=axis, keepdim=True, unbiased=False)
    return (x - m) / torch.sqrt(v + eps)
def _scatter_add(tgt, idx, src, axis=0):
    return tgt.clone().index_add_(axis, idx, src)
def _segment_sum(src, seg, n):
    out = torch.zeros((n,) + src.shape[1:], dtype=src.dtype)
    return out.index_add_(0, seg, src)
def _pad(x, pw):
    flat = tuple(v for pair in reversed(pw) for v in pair)
    return torch.nn.functional.pad(x, flat)

kernel_name = 'recurrent_scan__linear_kernel_hedgehog__mixer_s_mlp__prompt'

def setup_inputs():

    _w = (lambda a: (lambda t: t.to(torch.bfloat16) if t.is_floating_point() else t)(torch.as_tensor(a)))
    def _A_setup():
        B, S, D, H = 1, 2048, 512, 32
        Dh = D // H
        return {
            "x": _w((lambda *s: torch.randn(*s, dtype=torch.bfloat16) * 0.05)(B, S, D)),
            "wqkv": _w((lambda *s: torch.randn(*s, dtype=torch.bfloat16) * 0.2)(D, 3 * D)),
            "w_phi": _w((lambda *s: torch.randn(*s, dtype=torch.bfloat16) * 0.2)(H, Dh, Dh) * (Dh ** -0.5)),
            "wo": _w((lambda *s: torch.randn(*s, dtype=torch.bfloat16) * 0.05)(D, D)),
        }
    _A_in = _A_setup()

    def _B_setup():
        B, S, D, F = 1, 2048, 512, 1792
        return {
            "x":  _w((lambda *s: torch.randn(*s, dtype=torch.bfloat16) * 0.05)(B, S, D)),
            "w1": _w((lambda *s: torch.randn(*s, dtype=torch.bfloat16) * 0.8)(D, D) * (D ** -0.5)),
            "w2": _w((lambda *s: torch.randn(*s, dtype=torch.bfloat16) * 0.8)(D, D) * (D ** -0.5)),
            "w3": _w((lambda *s: torch.randn(*s, dtype=torch.bfloat16) * 0.8)(D, F) * (D ** -0.5)),
            "w4": _w((lambda *s: torch.randn(*s, dtype=torch.bfloat16) * 0.8)(F, D) * (F ** -0.5)),
        }
    _B_in = _B_setup()

    return {
        "A_x": _A_in["x"],
        "A_wqkv": _A_in["wqkv"],
        "A_w_phi": _A_in["w_phi"],
        "A_wo": _A_in["wo"],
        "B_x": _B_in["x"],
        "B_w1": _B_in["w1"],
        "B_w2": _B_in["w2"],
        "B_w3": _B_in["w3"],
        "B_w4": _B_in["w4"],
    }

def reference(A_x, A_wqkv, A_w_phi, A_wo, B_x, B_w1, B_w2, B_w3, B_w4):
    def _A_ref(x, wqkv, w_phi, wo):
        B, S, D = x.shape
        H = 32; Dh = D // H
        qkv = (lambda x, *d: x.permute(*d))((x @ wqkv).reshape(B, S, 3, H, Dh), 2, 0, 3, 1, 4)
        q, k, v = qkv[0], qkv[1], qkv[2]
        pq = torch.einsum("bhsd,hdf->bhsf", q, w_phi)
        pk = torch.einsum("bhsd,hdf->bhsf", k, w_phi)
        phi_q = torch.concatenate([_softmax(pq, axis=-1), _softmax(-pq, axis=-1)], axis=-1)
        phi_k = torch.concatenate([_softmax(pk, axis=-1), _softmax(-pk, axis=-1)], axis=-1)
        kv = torch.einsum("bhsf,bhsd->bhfd", phi_k, v)
        z  = torch.einsum("bhsf->bhf", phi_k)
        num = torch.einsum("bhqf,bhfd->bhqd", phi_q, kv)
        den = torch.einsum("bhqf,bhf->bhq", phi_q, z)[..., None] + 1e-6
        o = num / den
        return (lambda x, *d: x.permute(*d))(o, 0, 2, 1, 3).reshape(B, S, D) @ wo

    def _B_ref(x, w1, w2, w3, w4):
        B, S, D = x.shape
        h = _gelu(_layernorm(x, axis=-1) @ w1)
        c = D // 4
        g0 = _pad(h[:, :, 0*c:1*c], ((0, 0), (1, 0), (0, 0)))[:, :S, :]
        g1 = _pad(h[:, :, 1*c:2*c], ((0, 0), (0, 1), (0, 0)))[:, 1:, :]
        g2 = _pad(h[:, :, 2*c:3*c], ((0, 0), (2, 0), (0, 0)))[:, :S, :]
        g3 = _pad(h[:, :, 3*c:   ], ((0, 0), (0, 2), (0, 0)))[:, 2:, :]
        hs = torch.concatenate([g0, g1, g2, g3], axis=-1) @ w2
        x1 = x + hs
        h2 = _gelu(_layernorm(x1, axis=-1) @ w3) @ w4
        return x1 + h2

    x = A_x
    xn = _layernorm(x, axis=-1)
    s = _A_ref(xn, A_wqkv, A_w_phi, A_wo)
    g = _silu(_B_ref(xn, B_w1, B_w2, B_w3, B_w4))
    return x + s * g
```

```asm
; @launch grid=(256,1,1) block=(256,1,1) lds=163840
.amdgcn_target "amdgcn-amd-amdhsa--gfx950"
.text
.globl recurrent_scan__linear_kernel_hedgehog__mixer_s_mlp__prompt_kernel
.p2align 8
.type recurrent_scan__linear_kernel_hedgehog__mixer_s_mlp__prompt_kernel,@function
recurrent_scan__linear_kernel_hedgehog__mixer_s_mlp__prompt_kernel:
  s_cmp_ge_u32 s2, 256
  s_cbranch_scc1 L_end
  s_load_dwordx2 s[4:5], s[0:1], 0
  s_load_dwordx2 s[20:21], s[0:1], 40
  s_load_dwordx2 s[8:9], s[0:1], 8
  s_load_dwordx2 s[12:13], s[0:1], 16
  s_load_dwordx2 s[16:17], s[0:1], 24
  s_load_dwordx2 s[24:25], s[0:1], 48
  s_load_dwordx2 s[28:29], s[0:1], 56
  s_load_dwordx2 s[32:33], s[0:1], 64
  s_load_dwordx2 s[36:37], s[0:1], 72
  s_load_dwordx2 s[40:41], s[0:1], 88
  v_lshrrev_b32 v202, 6, v0
  v_and_b32 v1, 63, v0
  v_readfirstlane_b32 s50, v202
  s_and_b32 s60, s2, 1
  s_lshr_b32 s61, s2, 3
  s_bfe_u32 s62, s2, 0x20001
  s_lshr_b32 s70, s61, 2
  s_lshl3_add_u32 s48, s62, s70
  s_add_u32 s70, s61, 0
  s_and_b32 s70, s70, 3
  s_lshl2_add_u32 s49, s60, s70
  s_lshr_b32 s66, s50, 1
  s_and_b32 s67, s50, 1
  s_lshl_b32 s51, s50, 12
  s_lshl1_add_u32 s52, s48, s67
  s_lshl_b32 s52, s52, 8
  s_add_u32 s52, s52, s66
  s_lshl_b32 s52, s52, 7
  s_lshl_b32 s53, s50, 8
  s_add_u32 s53, s53, s49
  s_lshl_b32 s53, s53, 7
  s_mov_b32 s6, 2097152
  s_mov_b32 s7, 0x20000
  s_mov_b32 s22, 524288
  s_mov_b32 s23, 0x20000
  v_lshrrev_b32 v200, 3, v1
  v_and_b32 v201, 7, v1
  v_lshrrev_b32 v202, 4, v1
  v_xor_b32 v203, v201, v202
  v_lshlrev_b32 v203, 4, v203
  v_lshl_add_u32 v184, v200, 10, v203
  v_xor_b32 v185, 64, v184
  v_add_u32 v185, 7168, v185
  v_add_u32 v186, 14336, v184
  v_add_u32 v187, 14336, v185
  v_and_b32 v203, 1, v202
  v_lshlrev_b32 v203, 2, v203
  v_xor_b32 v203, v201, v203
  v_lshlrev_b32 v203, 4, v203
  v_lshl_add_u32 v4, v200, 10, v203
  v_add_u32 v5, 7168, v4
  v_add_u32 v6, 14336, v4
  v_add_u32 v7, 21504, v4
  s_lshl2_add_u32 s63, s61, s50
  s_waitcnt lgkmcnt(0)
  s_lshl_b32 s70, s62, 19
  s_add_u32 s70, s70, 512
  s_mul_i32 s71, s63, 16
  v_add_u32 v240, s71, v1
  v_lshrrev_b32 v241, 2, v240
  v_and_b32 v240, 3, v240
  v_mul_u32_u24 v241, 1024, v241
  v_lshl_add_u32 v240, v240, 7, v241
  s_mov_b64 exec, 0xffff
  buffer_load_dword v241, v240, s[4:7], s70 offen
  s_mov_b64 exec, -1
  s_lshl_b32 s70, s60, 9
  s_add_u32 s70, s70, 262144
  s_mul_i32 s71, s63, 8
  v_add_u32 v243, s71, v1
  v_lshrrev_b32 v244, 2, v243
  v_and_b32 v243, 3, v243
  v_mul_u32_u24 v244, 1024, v244
  v_lshl_add_u32 v243, v243, 7, v244
  s_mov_b64 exec, 0xff
  buffer_load_dword v244, v243, s[20:23], s70 offen
  s_mov_b64 exec, -1
  s_add_u32 s59, s52, 0
  s_add_u32 m0, s51, 0
  s_nop 0
  buffer_load_dwordx4 v184, s[4:7], s59 offen offset:0 lds
  buffer_load_dwordx4 v185, s[4:7], s59 offen offset:1024 lds
  buffer_load_dwordx4 v186, s[4:7], s59 offen offset:2048 lds
  buffer_load_dwordx4 v187, s[4:7], s59 offen offset:3072 lds
  s_add_u32 s59, s53, 0
  s_add_u32 m0, s51, 65536
  s_nop 0
  buffer_load_dwordx4 v4, s[20:23], s59 offen offset:0 lds
  buffer_load_dwordx4 v5, s[20:23], s59 offen offset:1024 lds
  buffer_load_dwordx4 v6, s[20:23], s59 offen offset:2048 lds
  buffer_load_dwordx4 v7, s[20:23], s59 offen offset:3072 lds
  s_mov_b32 s10, 1572864
  s_mov_b32 s11, 0x20000
  s_mov_b32 s14, 16384
  s_mov_b32 s15, 0x20000
  s_mov_b32 s18, 524288
  s_mov_b32 s19, 0x20000
  s_add_u32 s59, s52, 256
  s_add_u32 m0, s51, 16384
  s_nop 0
  buffer_load_dwordx4 v184, s[4:7], s59 offen offset:0 lds
  s_mov_b32 s26, 524288
  s_mov_b32 s27, 0x20000
  s_mov_b32 s34, 1835008
  s_mov_b32 s35, 0x20000
  s_mov_b32 s38, 2097152
  buffer_load_dwordx4 v185, s[4:7], s59 offen offset:1024 lds
  s_mov_b32 s39, 0x20000
  s_mov_b32 s42, 18350080
  s_mov_b32 s43, 0x20000
  s_mov_b32 s30, 1835008
  s_mov_b32 s31, 0x20000
  buffer_load_dwordx4 v186, s[4:7], s59 offen offset:2048 lds
  s_mov_b32 s47, 0x20000
  v_lshlrev_b32 v2, 4, v1
  s_lshr_b32 s70, s61, 3
  s_lshl2_add_u32 s64, s62, s70
  s_lshl2_add_u32 s64, s64, s50
  s_mul_i32 s65, s60, 7
  buffer_load_dwordx4 v187, s[4:7], s59 offen offset:3072 lds
  s_and_b32 s71, s61, 7
  s_add_u32 s65, s65, s71
  s_cmp_eq_u32 s71, 7
  s_cselect_b32 s30, 0, 1835008
  s_lshl_b32 s61, s49, 7
  s_mul_i32 s54, s50, 98304
  s_add_u32 s59, s53, 131072
  s_add_u32 m0, s51, 81920
  s_nop 0
  buffer_load_dwordx4 v4, s[20:23], s59 offen offset:0 lds
  s_add_u32 s54, s54, s61
  s_mul_i32 s55, s50, 114688
  s_lshl_b32 s60, s65, 8
  s_add_u32 s55, s55, s60
  s_lshl2_add_u32 s56, s66, s67
  buffer_load_dwordx4 v5, s[20:23], s59 offen offset:1024 lds
  s_lshl_b32 s56, s56, 15
  s_add_u32 s56, s56, s61
  s_or_b32 s57, s2, s50
  s_lshl1_add_u32 s73, s48, s66
  s_lshl1_add_u32 s3, s49, s67
  s_lshl_b32 s2, s73, 5
  buffer_load_dwordx4 v6, s[20:23], s59 offen offset:2048 lds
  s_add_u32 s2, s2, s3
  s_lshl_b32 s2, s2, 2
  v_mul_u32_u24 v8, 3072, v200
  v_add_u32 v8, v8, v203
  v_mul_u32_u24 v12, 3584, v200
  buffer_load_dwordx4 v7, s[20:23], s59 offen offset:3072 lds
  v_add_u32 v12, v12, v203
  v_add_u32 v9, 23552, v8
  v_add_u32 v13, 27648, v12
  v_add_u32 v10, 47104, v8
  v_add_u32 v14, 55296, v12
  s_add_u32 s59, s52, 512
  s_add_u32 m0, s51, 32768
  s_nop 0
  buffer_load_dwordx4 v184, s[4:7], s59 offen offset:0 lds
  v_add_u32 v11, 70656, v8
  v_add_u32 v15, 82944, v12
  s_mov_b32 s58, 0x3f803f80
  s_mov_b32 s68, 0x3fb8aa3b
  s_mov_b32 s69, 0x3fb8aa3b
  buffer_load_dwordx4 v185, s[4:7], s59 offen offset:1024 lds
  v_cmp_eq_u32 vcc, 0, v1
  v_mov_b32 v34, 0x80000000
  v_mov_b32 v36, 18202624
  v_cndmask_b32 v34, v34, 0, vcc
  buffer_load_dword v35, v36, s[40:43], 0 offen sc1
  v_and_b32 v204, 31, v1
  buffer_load_dwordx4 v186, s[4:7], s59 offen offset:2048 lds
  v_lshrrev_b32 v205, 5, v1
  v_bfe_u32 v206, v1, 2, 2
  v_and_b32 v207, 3, v1
  v_lshlrev_b32 v38, 4, v205
  v_bfe_u32 v203, v204, 1, 3
  buffer_load_dwordx4 v187, s[4:7], s59 offen offset:3072 lds
  v_xor_b32 v203, v203, v205
  v_lshlrev_b32 v203, 4, v203
  v_lshl_add_u32 v203, v204, 7, v203
  s_xor_b32 s70, s66, s67
  s_lshl_b32 s60, s70, 5
  s_add_u32 s59, s53, 262144
  s_add_u32 m0, s51, 98304
  s_nop 0
  buffer_load_dwordx4 v4, s[20:23], s59 offen offset:0 lds
  v_xor_b32 v203, s60, v203
  s_lshl_b32 s60, s66, 12
  v_add_u32 v188, s60, v203
  v_xor_b32 v189, 32, v188
  v_xor_b32 v190, 64, v188
  v_xor_b32 v191, 96, v188
  buffer_load_dwordx4 v5, s[20:23], s59 offen offset:1024 lds
  v_bfe_u32 v203, v1, 4, 1
  v_lshrrev_b32 v208, 1, v207
  v_lshl_or_b32 v203, v203, 1, v208
  v_lshrrev_b32 v208, 1, v206
  v_lshl_or_b32 v203, v208, 2, v203
  buffer_load_dwordx4 v6, s[20:23], s59 offen offset:2048 lds
  v_lshlrev_b32 v203, 4, v203
  v_and_b32 v208, 1, v207
  v_lshl_add_u32 v203, v208, 3, v203
  v_lshl_add_u32 v208, v205, 3, v206
  v_lshl_add_u32 v16, v208, 7, v203
  buffer_load_dwordx4 v7, s[20:23], s59 offen offset:3072 lds
  s_lshl_b32 s60, s67, 6
  v_xor_b32 v16, s60, v16
  s_lshl_b32 s61, s70, 11
  v_subrev_u32 v19, s61, v16
  v_add_u32 v16, s61, v16
  s_add_u32 s59, s52, 768
  s_add_u32 m0, s51, 49152
  s_nop 0
  buffer_load_dwordx4 v184, s[4:7], s59 offen offset:0 lds
  v_lshl_add_u32 v208, v205, 2, v206
  v_lshl_add_u32 v22, v208, 7, v203
  v_xor_b32 v25, 64, v22
  v_xor_b32 v28, s60, v22
  s_lshl_b32 s61, s67, 13
  v_add_u32 v28, s61, v28
  buffer_load_dwordx4 v185, s[4:7], s59 offen offset:1024 lds
  v_xor_b32 v31, 64, v28
  v_add_u32 v17, 0x10000, v16
  v_add_u32 v18, 0x20000, v16
  v_add_u32 v20, 0x10000, v19
  v_add_u32 v21, 0x20000, v19
  buffer_load_dwordx4 v186, s[4:7], s59 offen offset:2048 lds
  v_add_u32 v23, 0x10000, v22
  v_add_u32 v24, 0x20000, v22
  v_add_u32 v26, 0x10000, v25
  v_add_u32 v27, 0x20000, v25
  v_add_u32 v29, 0x10000, v28
  buffer_load_dwordx4 v187, s[4:7], s59 offen offset:3072 lds
  v_add_u32 v30, 0x20000, v28
  v_add_u32 v32, 0x10000, v31
  v_add_u32 v33, 0x20000, v31
  v_xor_b32 v208, v202, v1
  v_and_b32 v208, 1, v208
  v_cmp_eq_u32 vcc, 0, v208
  s_add_u32 s59, s53, 393216
  s_add_u32 m0, s51, 114688
  s_nop 0
  buffer_load_dwordx4 v4, s[20:23], s59 offen offset:0 lds
  v_mov_b32 v208, s58
  v_cndmask_b32 v48, 0, v208, vcc
  v_cndmask_b32 v49, 0, v208, vcc
  v_cndmask_b32 v50, 0, v208, vcc
  v_cndmask_b32 v51, 0, v208, vcc
  buffer_load_dwordx4 v5, s[20:23], s59 offen offset:1024 lds
  v_lshlrev_b32 v203, 3, v205
  v_lshl_add_u32 v203, v204, 10, v203
  s_lshl_b32 s60, s73, 9
  s_add_u32 s60, s60, s3
  s_lshl_b32 s60, s60, 6
  buffer_load_dwordx4 v6, s[20:23], s59 offen offset:2048 lds
  v_add_u32 v37, s60, v203
  s_lshr_b32 s60, s49, 2
  s_add_u32 s72, s60, 1
  s_sub_u32 s60, 0, s72
  s_bitcmp1_b32 s49, 1
  s_cselect_b32 s72, s60, s72
  buffer_load_dwordx4 v7, s[20:23], s59 offen offset:3072 lds
  v_cmp_gt_u32 vcc, 32, v1
  v_mov_b32 v203, 0x80000000
  s_lshl2_add_u32 s60, s49, s50
  s_lshl_b32 s60, s60, 9
  v_cndmask_b32 v203, v203, v2, vcc
  s_lshl_b32 s61, s50, 10
  s_add_u32 m0, s61, 147456
  s_nop 0
  buffer_load_dwordx4 v203, s[12:15], s60 offen lds
  buffer_load_dwordx2 v[52:53], v37, s[4:7], 0 offen offset:0
  buffer_load_dwordx2 v[54:55], v37, s[4:7], 0 offen offset:16
  buffer_load_dwordx2 v[56:57], v37, s[4:7], 0 offen offset:32
  buffer_load_dwordx2 v[58:59], v37, s[4:7], 0 offen offset:48
  s_lshl3_add_u32 s60, s48, s49
  s_lshr_b32 s61, s60, 2
  s_and_b32 s62, s60, 3
  s_lshl2_add_u32 s62, s62, s50
  s_cmp_lt_u32 s61, 24
  s_cselect_b64 vcc, -1, 0
  s_cselect_b32 s44, s8, s28
  s_cselect_b32 s45, s9, s29
  s_cselect_b32 s70, 6, 7
  s_cselect_b32 s71, 0, 24
  v_cndmask_b32 v192, v12, v8, vcc
  v_cndmask_b32 v193, v13, v9, vcc
  v_cndmask_b32 v194, v14, v10, vcc
  v_cndmask_b32 v195, v15, v11, vcc
  s_cmp_lt_u32 s61, 52
  s_cselect_b64 vcc, -1, 0
  s_cselect_b32 s44, s44, s24
  s_cselect_b32 s45, s45, s25
  s_cselect_b32 s70, s70, 2
  s_cselect_b32 s71, s71, 52
  v_cndmask_b32 v192, v4, v192, vcc
  v_cndmask_b32 v193, v5, v193, vcc
  v_cndmask_b32 v194, v6, v194, vcc
  v_cndmask_b32 v195, v7, v195, vcc
  s_lshl_b32 s46, s70, 18
  s_lshl_b32 s70, s70, 14
  s_sub_u32 s61, s61, s71
  s_mul_i32 s71, s62, s70
  s_lshl_b32 s61, s61, 7
  s_add_u32 s71, s71, s61
  s_cmp_lt_u32 s60, 240
  s_cselect_b32 s46, s46, 0
  s_add_u32 s59, s71, 0
  s_add_u32 m0, s51, 131072
  s_nop 0
  buffer_load_dwordx4 v192, s[44:47], s59 offen offset:0 lds
  buffer_load_dwordx4 v193, s[44:47], s59 offen offset:1024 lds
  buffer_load_dwordx4 v194, s[44:47], s59 offen offset:2048 lds
  buffer_load_dwordx4 v195, s[44:47], s59 offen offset:3072 lds
  s_mov_b32 s44, s40
  s_mov_b32 s45, s41
  s_cmp_eq_u32 s30, 0
  s_cselect_b32 s46, 0, 18350080
  s_and_b32 s61, s48, 7
  s_and_b32 s60, s49, 3
  s_lshl2_add_u32 s61, s61, s60
  s_lshl2_add_u32 s61, s61, s50
  s_or_b32 s60, s49, 3
  s_lshl_b32 s60, s60, 7
  v_lshrrev_b32 v254, 2, v1
  v_and_b32 v255, 3, v1
  v_mul_u32_u24 v255, 3072, v255
  v_lshl_add_u32 v255, v254, 10, v255
  s_mul_i32 s62, s61, 12288
  s_add_u32 s62, s62, s60
  s_mov_b64 exec, 0xfff
  buffer_load_dword v254, v255, s[8:11], s62 offen
  s_mov_b64 exec, 15
  v_lshlrev_b32 v255, 10, v1
  s_lshl_b32 s62, s61, 12
  s_add_u32 s62, s62, s60
  buffer_load_dword v254, v255, s[24:27], s62 offen
  s_mov_b64 exec, -1
  s_waitcnt vmcnt(36)
  s_barrier
  ds_read_b128 a[0:3], v188 offset:0
  ds_read_b64_tr_b16 v[80:81], v17 offset:0
  ds_read_b64_tr_b16 v[82:83], v17 offset:512
  ds_read_b128 a[4:7], v189 offset:0
  ds_read_b64_tr_b16 v[84:85], v20 offset:2048
  ds_read_b64_tr_b16 v[86:87], v20 offset:2560
  ds_read_b128 a[8:11], v190 offset:0
  ds_read_b64_tr_b16 v[88:89], v17 offset:4096
  ds_read_b64_tr_b16 v[90:91], v17 offset:4608
  ds_read_b128 a[12:15], v191 offset:0
  ds_read_b64_tr_b16 v[92:93], v20 offset:6144
  ds_read_b64_tr_b16 v[94:95], v20 offset:6656
  s_waitcnt lgkmcnt(9)
  v_mfma_f32_32x32x16_bf16 v[104:119], v[80:83], a[0:3], 0
  v_mfma_f32_16x16x32_bf16 v[136:139], a[0:3], v[48:51], 0
  v_mfma_f32_16x16x32_bf16 v[76:79], v[80:83], v[48:51], 0
  ds_read_b128 a[16:19], v188 offset:8192
  ds_read_b64_tr_b16 v[96:97], v17 offset:8192
  ds_read_b64_tr_b16 v[98:99], v17 offset:8704
  s_waitcnt lgkmcnt(9)
  v_mfma_f32_32x32x16_bf16 v[104:119], v[84:87], a[4:7], v[104:119]
  v_mfma_f32_32x32x16_bf16 v[120:135], a[0:3], a[0:3], 0
  ds_read_b128 a[20:23], v189 offset:8192
  ds_read_b64_tr_b16 v[100:101], v20 offset:10240
  ds_read_b64_tr_b16 v[102:103], v20 offset:10752
  s_waitcnt lgkmcnt(9)
  v_mfma_f32_32x32x16_bf16 v[104:119], v[88:91], a[8:11], v[104:119]
  v_mfma_f32_16x16x32_bf16 v[136:139], a[8:11], v[48:51], v[136:139]
  v_mfma_f32_16x16x32_bf16 v[76:79], v[88:91], v[48:51], v[76:79]
  ds_read_b128 a[24:27], v190 offset:8192
  ds_read_b64_tr_b16 v[80:81], v17 offset:12288
  ds_read_b64_tr_b16 v[82:83], v17 offset:12800
  s_waitcnt lgkmcnt(9)
  v_mfma_f32_32x32x16_bf16 v[104:119], v[92:95], a[12:15], v[104:119]
  v_mfma_f32_32x32x16_bf16 v[120:135], a[8:11], a[8:11], v[120:135]
  ds_read_b128 a[28:31], v191 offset:8192
  ds_read_b64_tr_b16 v[84:85], v20 offset:14336
  ds_read_b64_tr_b16 v[86:87], v20 offset:14848
  s_waitcnt lgkmcnt(9)
  v_mfma_f32_32x32x16_bf16 v[104:119], v[96:99], a[16:19], v[104:119]
  v_mfma_f32_16x16x32_bf16 v[136:139], a[16:19], v[48:51], v[136:139]
  v_mfma_f32_16x16x32_bf16 v[76:79], v[96:99], v[48:51], v[76:79]
  s_waitcnt vmcnt(28)
  s_waitcnt lgkmcnt(0)
  s_barrier
  ds_read_b128 a[32:35], v188 offset:16384
  ds_read_b64_tr_b16 v[88:89], v17 offset:16384
  ds_read_b64_tr_b16 v[90:91], v17 offset:16896
  v_mfma_f32_32x32x16_bf16 v[104:119], v[100:103], a[20:23], v[104:119]
  v_mfma_f32_32x32x16_bf16 v[120:135], a[16:19], a[16:19], v[120:135]
  ds_read_b128 a[36:39], v189 offset:16384
  ds_read_b64_tr_b16 v[92:93], v20 offset:18432
  ds_read_b64_tr_b16 v[94:95], v20 offset:18944
  v_mfma_f32_32x32x16_bf16 v[104:119], v[80:83], a[24:27], v[104:119]
  v_mfma_f32_16x16x32_bf16 v[136:139], a[24:27], v[48:51], v[136:139]
  v_mfma_f32_16x16x32_bf16 v[76:79], v[80:83], v[48:51], v[76:79]
  ds_read_b128 a[40:43], v190 offset:16384
  ds_read_b64_tr_b16 v[96:97], v17 offset:20480
  ds_read_b64_tr_b16 v[98:99], v17 offset:20992
  v_mfma_f32_32x32x16_bf16 v[104:119], v[84:87], a[28:31], v[104:119]
  v_mfma_f32_32x32x16_bf16 v[120:135], a[24:27], a[24:27], v[120:135]
  ds_read_b128 a[44:47], v191 offset:16384
  ds_read_b64_tr_b16 v[100:101], v20 offset:22528
  ds_read_b64_tr_b16 v[102:103], v20 offset:23040
  s_waitcnt lgkmcnt(9)
  v_mfma_f32_32x32x16_bf16 v[104:119], v[88:91], a[32:35], v[104:119]
  v_mfma_f32_16x16x32_bf16 v[136:139], a[32:35], v[48:51], v[136:139]
  v_mfma_f32_16x16x32_bf16 v[76:79], v[88:91], v[48:51], v[76:79]
  s_add_u32 s59, s54, 1024
  s_add_u32 m0, s51, 0
  s_nop 0
  buffer_load_dwordx4 v8, s[8:11], s59 offen offset:0 lds
  v_and_b32 v202, 31, v1
  ds_read_b128 a[48:51], v188 offset:24576
  ds_read_b64_tr_b16 v[80:81], v17 offset:24576
  ds_read_b64_tr_b16 v[82:83], v17 offset:25088
  s_waitcnt lgkmcnt(9)
  v_mfma_f32_32x32x16_bf16 v[104:119], v[92:95], a[36:39], v[104:119]
  v_mfma_f32_32x32x16_bf16 v[120:135], a[32:35], a[32:35], v[120:135]
  s_lshl_b32 s60, s66, 7
  s_add_u32 s60, s60, 151552
  v_lshl_add_u32 v200, v202, 2, s60
  ds_read_b128 a[52:55], v189 offset:24576
  ds_read_b64_tr_b16 v[84:85], v20 offset:26624
  ds_read_b64_tr_b16 v[86:87], v20 offset:27136
  s_waitcnt lgkmcnt(9)
  v_mfma_f32_32x32x16_bf16 v[104:119], v[96:99], a[40:43], v[104:119]
  v_mfma_f32_16x16x32_bf16 v[136:139], a[40:43], v[48:51], v[136:139]
  v_mfma_f32_16x16x32_bf16 v[76:79], v[96:99], v[48:51], v[76:79]
  buffer_load_dwordx4 v9, s[8:11], s59 offen offset:1024 lds
  s_lshl_b32 s60, s67, 9
  v_add_u32 v201, s60, v200
  ds_read_b128 a[56:59], v190 offset:24576
  ds_read_b64_tr_b16 v[88:89], v17 offset:28672
  ds_read_b64_tr_b16 v[90:91], v17 offset:29184
  s_waitcnt lgkmcnt(9)
  v_mfma_f32_32x32x16_bf16 v[104:119], v[100:103], a[44:47], v[104:119]
  v_mfma_f32_32x32x16_bf16 v[120:135], a[40:43], a[40:43], v[120:135]
  s_lshl_b32 s60, s73, 5
  v_add_u32 v204, s60, v202
  ds_read_b128 a[60:63], v191 offset:24576
  ds_read_b64_tr_b16 v[92:93], v20 offset:30720
  ds_read_b64_tr_b16 v[94:95], v20 offset:31232
  s_waitcnt lgkmcnt(9)
  v_mfma_f32_32x32x16_bf16 v[104:119], v[80:83], a[48:51], v[104:119]
  v_mfma_f32_16x16x32_bf16 v[136:139], a[48:51], v[48:51], v[136:139]
  v_mfma_f32_16x16x32_bf16 v[76:79], v[80:83], v[48:51], v[76:79]
  buffer_load_dwordx4 v10, s[8:11], s59 offen offset:2048 lds
  v_add_u32 v202, s72, v204
  s_waitcnt vmcnt(22)
  s_waitcnt lgkmcnt(0)
  s_barrier
  ds_read_b128 a[64:67], v188 offset:32768
  ds_read_b64_tr_b16 v[96:97], v17 offset:32768
  ds_read_b64_tr_b16 v[98:99], v17 offset:33280
  v_mfma_f32_32x32x16_bf16 v[104:119], v[84:87], a[52:55], v[104:119]
  v_mfma_f32_32x32x16_bf16 v[120:135], a[48:51], a[48:51], v[120:135]
  v_lshrrev_b32 v205, 5, v202
  ds_read_b128 a[68:71], v189 offset:32768
  ds_read_b64_tr_b16 v[100:101], v20 offset:34816
  ds_read_b64_tr_b16 v[102:103], v20 offset:35328
  v_mfma_f32_32x32x16_bf16 v[104:119], v[88:91], a[56:59], v[104:119]
  v_mfma_f32_16x16x32_bf16 v[136:139], a[56:59], v[48:51], v[136:139]
  v_mfma_f32_16x16x32_bf16 v[76:79], v[88:91], v[48:51], v[76:79]
  buffer_load_dwordx4 v11, s[8:11], s59 offen offset:3072 lds
  v_and_b32 v203, 31, v202
  ds_read_b128 a[72:75], v190 offset:32768
  ds_read_b64_tr_b16 v[80:81], v17 offset:36864
  ds_read_b64_tr_b16 v[82:83], v17 offset:37376
  v_mfma_f32_32x32x16_bf16 v[104:119], v[92:95], a[60:63], v[104:119]
  v_mfma_f32_32x32x16_bf16 v[120:135], a[56:59], a[56:59], v[120:135]
  v_lshl_add_u32 v203, v38, 1, v203
  ds_read_b128 a[76:79], v191 offset:32768
  ds_read_b64_tr_b16 v[84:85], v20 offset:38912
  ds_read_b64_tr_b16 v[86:87], v20 offset:39424
  s_waitcnt lgkmcnt(9)
  v_mfma_f32_32x32x16_bf16 v[104:119], v[96:99], a[64:67], v[104:119]
  v_mfma_f32_16x16x32_bf16 v[136:139], a[64:67], v[48:51], v[136:139]
  v_mfma_f32_16x16x32_bf16 v[76:79], v[96:99], v[48:51], v[76:79]
  s_add_u32 s59, s54, 394240
  s_add_u32 m0, s51, 65536
  s_nop 0
  buffer_load_dwordx4 v8, s[8:11], s59 offen offset:0 lds
  v_lshlrev_b32 v203, 4, v203
  ds_read_b128 a[80:83], v188 offset:40960
  ds_read_b64_tr_b16 v[88:89], v17 offset:40960
  ds_read_b64_tr_b16 v[90:91], v17 offset:41472
  s_waitcnt lgkmcnt(9)
  v_mfma_f32_32x32x16_bf16 v[104:119], v[100:103], a[68:71], v[104:119]
  v_mfma_f32_32x32x16_bf16 v[120:135], a[64:67], a[64:67], v[120:135]
  v_lshl_add_u32 v203, v205, 15, v203
  ds_read_b128 a[84:87], v189 offset:40960
  ds_read_b64_tr_b16 v[92:93], v20 offset:43008
  ds_read_b64_tr_b16 v[94:95], v20 offset:43520
  s_waitcnt lgkmcnt(9)
  v_mfma_f32_32x32x16_bf16 v[104:119], v[80:83], a[72:75], v[104:119]
  v_mfma_f32_16x16x32_bf16 v[136:139], a[72:75], v[48:51], v[136:139]
  v_mfma_f32_16x16x32_bf16 v[76:79], v[80:83], v[48:51], v[76:79]
  buffer_load_dwordx4 v9, s[8:11], s59 offen offset:1024 lds
  v_cmp_gt_u32 vcc, 2048, v202
  ds_read_b128 a[88:91], v190 offset:40960
  ds_read_b64_tr_b16 v[96:97], v17 offset:45056
  ds_read_b64_tr_b16 v[98:99], v17 offset:45568
  s_waitcnt lgkmcnt(9)
  v_mfma_f32_32x32x16_bf16 v[104:119], v[84:87], a[76:79], v[104:119]
  v_mfma_f32_32x32x16_bf16 v[120:135], a[72:75], a[72:75], v[120:135]
  v_mov_b32 v205, 0x80000000
  ds_read_b128 a[92:95], v191 offset:40960
  ds_read_b64_tr_b16 v[100:101], v20 offset:47104
  ds_read_b64_tr_b16 v[102:103], v20 offset:47616
  s_waitcnt lgkmcnt(9)
  v_mfma_f32_32x32x16_bf16 v[104:119], v[88:91], a[80:83], v[104:119]
  v_mfma_f32_16x16x32_bf16 v[136:139], a[80:83], v[48:51], v[136:139]
  v_mfma_f32_16x16x32_bf16 v[76:79], v[88:91], v[48:51], v[76:79]
  buffer_load_dwordx4 v10, s[8:11], s59 offen offset:2048 lds
  v_and_b32 v206, 48, v1
  s_waitcnt vmcnt(18)
  s_waitcnt lgkmcnt(0)
  s_barrier
  ds_read_b128 a[96:99], v188 offset:49152
  ds_read_b64_tr_b16 v[80:81], v17 offset:49152
  ds_read_b64_tr_b16 v[82:83], v17 offset:49664
  v_mfma_f32_32x32x16_bf16 v[104:119], v[92:95], a[84:87], v[104:119]
  v_mfma_f32_32x32x16_bf16 v[120:135], a[80:83], a[80:83], v[120:135]
  v_cndmask_b32 v203, v205, v203, vcc
  ds_read_b128 a[100:103], v189 offset:49152
  ds_read_b64_tr_b16 v[84:85], v20 offset:51200
  ds_read_b64_tr_b16 v[86:87], v20 offset:51712
  v_mfma_f32_32x32x16_bf16 v[104:119], v[96:99], a[88:91], v[104:119]
  v_mfma_f32_16x16x32_bf16 v[136:139], a[88:91], v[48:51], v[136:139]
  v_mfma_f32_16x16x32_bf16 v[76:79], v[96:99], v[48:51], v[76:79]
  buffer_load_dwordx4 v11, s[8:11], s59 offen offset:3072 lds
  v_and_b32 v207, 1, v1
  ds_read_b128 a[104:107], v190 offset:49152
  ds_read_b64_tr_b16 v[88:89], v17 offset:53248
  ds_read_b64_tr_b16 v[90:91], v17 offset:53760
  v_mfma_f32_32x32x16_bf16 v[104:119], v[100:103], a[92:95], v[104:119]
  v_mfma_f32_32x32x16_bf16 v[120:135], a[88:91], a[88:91], v[120:135]
  v_lshl_add_u32 v206, v207, 6, v206
  ds_read_b128 a[108:111], v191 offset:49152
  ds_read_b64_tr_b16 v[92:93], v20 offset:55296
  ds_read_b64_tr_b16 v[94:95], v20 offset:55808
  s_waitcnt lgkmcnt(9)
  v_mfma_f32_32x32x16_bf16 v[104:119], v[80:83], a[96:99], v[104:119]
  v_mfma_f32_16x16x32_bf16 v[136:139], a[96:99], v[48:51], v[136:139]
  v_mfma_f32_16x16x32_bf16 v[76:79], v[80:83], v[48:51], v[76:79]
  s_add_u32 s59, s54, 787456
  s_add_u32 m0, s51, 16384
  s_nop 0
  buffer_load_dwordx4 v8, s[8:11], s59 offen offset:0 lds
  s_lshl_b32 s60, s50, 7
  s_add_u32 s60, s60, 153088
  v_add_u32 v207, s60, v206
  ds_read_b128 a[112:115], v188 offset:57344
  ds_read_b64_tr_b16 v[96:97], v17 offset:57344
  ds_read_b64_tr_b16 v[98:99], v17 offset:57856
  s_waitcnt lgkmcnt(9)
  v_mfma_f32_32x32x16_bf16 v[104:119], v[84:87], a[100:103], v[104:119]
  v_mfma_f32_32x32x16_bf16 v[120:135], a[96:99], a[96:99], v[120:135]
  s_lshl_b32 s60, s67, 2
  s_add_u32 s60, s60, s66
  s_lshl_b32 s60, s60, 7
  s_add_u32 s60, s60, 151552
  v_add_u32 v206, s60, v206
  ds_read_b128 a[116:119], v189 offset:57344
  ds_read_b64_tr_b16 v[100:101], v20 offset:59392
  ds_read_b64_tr_b16 v[102:103], v20 offset:59904
  s_waitcnt lgkmcnt(9)
  v_mfma_f32_32x32x16_bf16 v[104:119], v[88:91], a[104:107], v[104:119]
  v_mfma_f32_16x16x32_bf16 v[136:139], a[104:107], v[48:51], v[136:139]
  v_mfma_f32_16x16x32_bf16 v[76:79], v[88:91], v[48:51], v[76:79]
  buffer_load_dwordx4 v9, s[8:11], s59 offen offset:1024 lds
  s_lshl_b32 s60, s67, 7
  s_add_u32 s60, s60, 153088
  v_add_u32 v208, s60, v38
  ds_read_b128 a[120:123], v190 offset:57344
  ds_read_b64_tr_b16 v[80:81], v17 offset:61440
  ds_read_b64_tr_b16 v[82:83], v17 offset:61952
  s_waitcnt lgkmcnt(9)
  v_mfma_f32_32x32x16_bf16 v[104:119], v[92:95], a[108:111], v[104:119]
  v_mfma_f32_32x32x16_bf16 v[120:135], a[104:107], a[104:107], v[120:135]
  v_readfirstlane_b32 s60, v35
  s_nop 0
  s_mul_i32 s60, s60, 1664525
  s_add_u32 s60, s60, 1013904223
  v_mov_b32 v3, s60
  ds_read_b128 a[124:127], v191 offset:57344
  ds_read_b64_tr_b16 v[84:85], v20 offset:63488
  ds_read_b64_tr_b16 v[86:87], v20 offset:64000
  s_waitcnt lgkmcnt(9)
  v_mfma_f32_32x32x16_bf16 v[104:119], v[96:99], a[112:115], v[104:119]
  v_mfma_f32_16x16x32_bf16 v[136:139], a[112:115], v[48:51], v[136:139]
  v_mfma_f32_16x16x32_bf16 v[76:79], v[96:99], v[48:51], v[76:79]
  buffer_load_dwordx4 v10, s[8:11], s59 offen offset:2048 lds
  s_waitcnt lgkmcnt(6)
  v_mfma_f32_32x32x16_bf16 v[104:119], v[100:103], a[116:119], v[104:119]
  v_mfma_f32_32x32x16_bf16 v[120:135], a[112:115], a[112:115], v[120:135]
  s_waitcnt lgkmcnt(3)
  v_mfma_f32_32x32x16_bf16 v[104:119], v[80:83], a[120:123], v[104:119]
  v_mfma_f32_16x16x32_bf16 v[136:139], a[120:123], v[48:51], v[136:139]
  v_mfma_f32_16x16x32_bf16 v[76:79], v[80:83], v[48:51], v[76:79]
  buffer_load_dwordx4 v11, s[8:11], s59 offen offset:3072 lds
  s_waitcnt lgkmcnt(0)
  v_mfma_f32_32x32x16_bf16 v[104:119], v[84:87], a[124:127], v[104:119]
  v_mfma_f32_32x32x16_bf16 v[120:135], a[120:123], a[120:123], v[120:135]
  s_mov_b32 s74, 0xaaaaaaaa
  s_mov_b32 s75, 0xaaaaaaaa
  s_nop 9
  v_cndmask_b32 v120, v120, v121, s[74:75]
  v_cndmask_b32 v122, v122, v123, s[74:75]
  v_cndmask_b32 v124, v124, v125, s[74:75]
  v_cndmask_b32 v126, v126, v127, s[74:75]
  v_cndmask_b32 v128, v128, v129, s[74:75]
  v_cndmask_b32 v130, v130, v131, s[74:75]
  v_cndmask_b32 v132, v132, v133, s[74:75]
  v_cndmask_b32 v134, v134, v135, s[74:75]
  s_mov_b32 s74, 0xcccccccc
  s_mov_b32 s75, 0xcccccccc
  v_cndmask_b32 v120, v120, v122, s[74:75]
  v_cndmask_b32 v124, v124, v126, s[74:75]
  v_cndmask_b32 v128, v128, v130, s[74:75]
  v_cndmask_b32 v132, v132, v134, s[74:75]
  s_mov_b32 s74, 0xff00ff00
  s_mov_b32 s75, 0xff00ff00
  v_cndmask_b32 v120, v120, v124, s[74:75]
  v_cndmask_b32 v128, v128, v132, s[74:75]
  s_mov_b32 s74, 0xffff0000
  s_mov_b32 s75, 0xffff0000
  v_cndmask_b32 v120, v120, v128, s[74:75]
  s_mov_b32 exec_lo, 0x0f0f0f0f
  s_mov_b32 exec_hi, 0xf0f0f0f0
  ds_write_b32 v201, v120 offset:256
  s_mov_b32 exec_lo, 0x00030003
  s_mov_b32 exec_hi, 0x00030003
  ds_write_b128 v206, v[136:139]
  ds_write_b128 v207, v[76:79]
  s_mov_b64 exec, -1
  s_waitcnt vmcnt(14)
  s_waitcnt lgkmcnt(0)
  s_barrier
  ds_read2st64_b32 v[68:69], v200 offset0:0 offset1:2
  ds_read2st64_b32 v[70:71], v200 offset0:1 offset1:3
  ds_read_b128 v[120:123], v208 offset:0
  ds_read_b128 v[136:139], v208 offset:256
  ds_read_b128 v[124:127], v208 offset:32
  ds_read_b128 v[140:143], v208 offset:288
  ds_read_b128 v[128:131], v208 offset:64
  ds_read_b128 v[144:147], v208 offset:320
  ds_read_b128 v[132:135], v208 offset:96
  ds_read_b128 v[148:151], v208 offset:352
  s_lshl_b32 s62, s3, 11
  s_waitcnt lgkmcnt(9)
  v_add_f32 v68, v68, v69
  s_waitcnt lgkmcnt(8)
  v_add_f32 v70, v70, v71
  v_mul_f32 v42, 0x3b000000, v68
  v_mul_f32 v70, 0x3b000000, v70
  v_fma_f32 v70, -v42, v42, v70
  v_max_f32 v70, 0, v70
  v_cvt_pk_bf16_f32 v70, v70, v70
  v_and_b32 v70, 0xffff0000, v70
  v_add_f32 v69, 0x3727c5ac, v70
  v_cvt_pk_bf16_f32 v69, v69, v69
  v_and_b32 v69, 0xffff0000, v69
  v_sqrt_f32 v68, v69
  v_cvt_pk_bf16_f32 v42, v42, v42
  v_and_b32 v42, 0xffff0000, v42
  v_cvt_pk_bf16_f32 v68, v68, v68
  v_and_b32 v68, 0xffff0000, v68
  v_rcp_f32 v44, v68
  s_add_u32 s59, s54, 1180672
  s_add_u32 m0, s51, 81920
  s_nop 0
  buffer_load_dwordx4 v8, s[8:11], s59 offen offset:0 lds
  ds_write_b32 v200, v42 offset:1024
  ds_write_b32 v200, v44 offset:1280
  v_mul_f32 v70, v70, v44
  v_mul_f32 v70, v70, v44
  v_cvt_pk_bf16_f32 v70, v70, v70
  v_and_b32 v70, 0xffff0000, v70
  v_add_f32 v70, 0x3727c5ac, v70
  v_cvt_pk_bf16_f32 v70, v70, v70
  v_and_b32 v70, 0xffff0000, v70
  v_sqrt_f32 v70, v70
  v_sub_f32 v42, 0, v42
  v_cvt_pk_bf16_f32 v70, v70, v70
  v_and_b32 v70, 0xffff0000, v70
  v_mul_f32 v212, v68, v70
  v_rcp_f32 v71, v212
  s_waitcnt lgkmcnt(8)
  v_pk_add_f32 v[120:121], v[120:121], v[136:137]
  v_pk_add_f32 v[122:123], v[122:123], v[138:139]
  s_waitcnt lgkmcnt(6)
  v_pk_add_f32 v[124:125], v[124:125], v[140:141]
  v_pk_add_f32 v[126:127], v[126:127], v[142:143]
  s_waitcnt lgkmcnt(4)
  v_pk_add_f32 v[128:129], v[128:129], v[144:145]
  v_pk_add_f32 v[130:131], v[130:131], v[146:147]
  s_waitcnt lgkmcnt(2)
  v_pk_add_f32 v[132:133], v[132:133], v[148:149]
  v_pk_add_f32 v[134:135], v[134:135], v[150:151]
  v_mul_f32 v208, 0xc0135761, v71
  v_mul_f32 v210, v71, v71
  v_mul_f32 v210, v210, v71
  v_mul_f32 v210, 0xbdd2d3e8, v210
  v_pk_fma_f32 v[104:105], v[120:121], v[42:43], v[104:105] op_sel_hi:[1,0,1]
  v_pk_fma_f32 v[106:107], v[122:123], v[42:43], v[106:107] op_sel_hi:[1,0,1]
  v_pk_fma_f32 v[108:109], v[124:125], v[42:43], v[108:109] op_sel_hi:[1,0,1]
  v_pk_fma_f32 v[110:111], v[126:127], v[42:43], v[110:111] op_sel_hi:[1,0,1]
  v_pk_mul_f32 v[224:225], v[104:105], v[104:105]
  v_pk_mul_f32 v[226:227], v[106:107], v[106:107]
  v_pk_mul_f32 v[228:229], v[108:109], v[108:109]
  v_pk_mul_f32 v[230:231], v[110:111], v[110:111]
  v_pk_fma_f32 v[224:225], v[224:225], v[210:211], v[208:209] op_sel_hi:[1,0,0]
  v_pk_fma_f32 v[226:227], v[226:227], v[210:211], v[208:209] op_sel_hi:[1,0,0]
  v_pk_fma_f32 v[228:229], v[228:229], v[210:211], v[208:209] op_sel_hi:[1,0,0]
  buffer_load_dwordx4 v9, s[8:11], s59 offen offset:1024 lds
  v_pk_fma_f32 v[230:231], v[230:231], v[210:211], v[208:209] op_sel_hi:[1,0,0]
  v_pk_mul_f32 v[224:225], v[224:225], v[104:105]
  v_pk_mul_f32 v[226:227], v[226:227], v[106:107]
  v_pk_mul_f32 v[228:229], v[228:229], v[108:109]
  v_pk_mul_f32 v[230:231], v[230:231], v[110:111]
  v_exp_f32 v224, v224
  v_exp_f32 v226, v226
  v_exp_f32 v228, v228
  v_exp_f32 v230, v230
  v_exp_f32 v225, v225
  v_exp_f32 v227, v227
  buffer_load_dwordx4 v10, s[8:11], s59 offen offset:2048 lds
  v_exp_f32 v229, v229
  v_exp_f32 v231, v231
  v_pk_fma_f32 v[224:225], v[224:225], v[212:213], v[212:213] op_sel_hi:[1,0,0]
  v_pk_fma_f32 v[226:227], v[226:227], v[212:213], v[212:213] op_sel_hi:[1,0,0]
  v_pk_fma_f32 v[228:229], v[228:229], v[212:213], v[212:213] op_sel_hi:[1,0,0]
  v_pk_fma_f32 v[230:231], v[230:231], v[212:213], v[212:213] op_sel_hi:[1,0,0]
  v_rcp_f32 v224, v224
  v_rcp_f32 v226, v226
  v_rcp_f32 v228, v228
  v_rcp_f32 v230, v230
  v_rcp_f32 v225, v225
  buffer_load_dwordx4 v11, s[8:11], s59 offen offset:3072 lds
  v_rcp_f32 v227, v227
  v_rcp_f32 v229, v229
  v_rcp_f32 v231, v231
  v_pk_mul_f32 v[224:225], v[224:225], v[104:105]
  v_pk_mul_f32 v[226:227], v[226:227], v[106:107]
  v_pk_mul_f32 v[228:229], v[228:229], v[108:109]
  v_pk_mul_f32 v[230:231], v[230:231], v[110:111]
  v_cvt_pk_bf16_f32 v216, v224, v225
  v_cvt_pk_bf16_f32 v217, v226, v227
  v_cvt_pk_bf16_f32 v218, v228, v229
  v_cvt_pk_bf16_f32 v219, v230, v231
  s_add_u32 s59, s54, 2048
  s_add_u32 m0, s51, 32768
  s_nop 0
  buffer_load_dwordx4 v8, s[8:11], s59 offen offset:0 lds
  buffer_store_dwordx4 v[216:219], v203, s[40:43], s62 offen sc1
  v_pk_fma_f32 v[112:113], v[128:129], v[42:43], v[112:113] op_sel_hi:[1,0,1]
  v_pk_fma_f32 v[114:115], v[130:131], v[42:43], v[114:115] op_sel_hi:[1,0,1]
  v_pk_fma_f32 v[116:117], v[132:133], v[42:43], v[116:117] op_sel_hi:[1,0,1]
  v_pk_fma_f32 v[118:119], v[134:135], v[42:43], v[118:119] op_sel_hi:[1,0,1]
  v_pk_mul_f32 v[224:225], v[112:113], v[112:113]
  v_pk_mul_f32 v[226:227], v[114:115], v[114:115]
  v_pk_mul_f32 v[228:229], v[116:117], v[116:117]
  v_pk_mul_f32 v[230:231], v[118:119], v[118:119]
  v_pk_fma_f32 v[224:225], v[224:225], v[210:211], v[208:209] op_sel_hi:[1,0,0]
  v_pk_fma_f32 v[226:227], v[226:227], v[210:211], v[208:209] op_sel_hi:[1,0,0]
  v_pk_fma_f32 v[228:229], v[228:229], v[210:211], v[208:209] op_sel_hi:[1,0,0]
  buffer_load_dwordx4 v9, s[8:11], s59 offen offset:1024 lds
  v_pk_fma_f32 v[230:231], v[230:231], v[210:211], v[208:209] op_sel_hi:[1,0,0]
  v_pk_mul_f32 v[224:225], v[224:225], v[112:113]
  v_pk_mul_f32 v[226:227], v[226:227], v[114:115]
  v_pk_mul_f32 v[228:229], v[228:229], v[116:117]
  v_pk_mul_f32 v[230:231], v[230:231], v[118:119]
  v_exp_f32 v224, v224
  v_exp_f32 v226, v226
  v_exp_f32 v228, v228
  v_exp_f32 v230, v230
  v_exp_f32 v225, v225
  v_exp_f32 v227, v227
  buffer_load_dwordx4 v10, s[8:11], s59 offen offset:2048 lds
  v_exp_f32 v229, v229
  v_exp_f32 v231, v231
  v_pk_fma_f32 v[224:225], v[224:225], v[212:213], v[212:213] op_sel_hi:[1,0,0]
  v_pk_fma_f32 v[226:227], v[226:227], v[212:213], v[212:213] op_sel_hi:[1,0,0]
  v_pk_fma_f32 v[228:229], v[228:229], v[212:213], v[212:213] op_sel_hi:[1,0,0]
  v_pk_fma_f32 v[230:231], v[230:231], v[212:213], v[212:213] op_sel_hi:[1,0,0]
  v_rcp_f32 v224, v224
  v_rcp_f32 v226, v226
  v_rcp_f32 v228, v228
  v_rcp_f32 v230, v230
  v_rcp_f32 v225, v225
  buffer_load_dwordx4 v11, s[8:11], s59 offen offset:3072 lds
  v_rcp_f32 v227, v227
  v_rcp_f32 v229, v229
  v_rcp_f32 v231, v231
  v_pk_mul_f32 v[224:225], v[224:225], v[112:113]
  v_pk_mul_f32 v[226:227], v[226:227], v[114:115]
  v_pk_mul_f32 v[228:229], v[228:229], v[116:117]
  v_pk_mul_f32 v[230:231], v[230:231], v[118:119]
  v_cvt_pk_bf16_f32 v220, v224, v225
  v_cvt_pk_bf16_f32 v221, v226, v227
  v_cvt_pk_bf16_f32 v222, v228, v229
  v_cvt_pk_bf16_f32 v223, v230, v231
  s_add_u32 s59, s54, 395264
  s_add_u32 m0, s51, 98304
  s_nop 0
  buffer_load_dwordx4 v8, s[8:11], s59 offen offset:0 lds
  buffer_store_dwordx4 v[220:223], v203, s[40:43], s62 offen offset:1024 sc1
  s_add_u32 s60, s48, 1
  s_and_b32 s60, s60, 30
  s_cbranch_scc1 L_nz_1
  v_subrev_u32 v202, s72, v204
  v_lshrrev_b32 v201, 5, v204
  v_and_b32 v203, 31, v204
  v_lshl_add_u32 v203, v38, 1, v203
  v_lshlrev_b32 v203, 4, v203
  v_lshl_add_u32 v203, v201, 15, v203
  v_cmp_lt_u32 vcc, 2047, v202
  v_mov_b32 v224, 0
  v_mov_b32 v225, 0
  v_mov_b32 v226, 0
  v_mov_b32 v227, 0
  v_cndmask_b32 v203, v205, v203, vcc
  buffer_store_dwordx4 v[224:227], v203, s[40:43], s62 offen sc1
  buffer_store_dwordx4 v[224:227], v203, s[40:43], s62 offen offset:1024 sc1
L_nz_1:
  v_bfe_u32 v200, v1, 2, 2
  v_lshrrev_b32 v201, 4, v1
  v_lshl_add_u32 v200, v201, 3, v200
  v_lshlrev_b32 v200, 7, v200
  v_and_b32 v201, 3, v1
  v_lshl_add_u32 v200, v201, 3, v200
  v_and_b32 v201, 8, v1
  s_lshl_b32 s60, s50, 5
  v_lshlrev_b32 v201, 3, v201
  v_xor_b32 v201, s60, v201
  s_mov_b32 s60, 131072
  v_add3_u32 v200, v200, v201, s60
  ds_read_b64_tr_b16 v[80:81], v200 offset:0
  ds_read_b64_tr_b16 v[82:83], v200 offset:512
  ds_read_b64_tr_b16 v[84:85], v200 offset:4096
  ds_read_b64_tr_b16 v[86:87], v200 offset:4608
  ds_read_b64_tr_b16 v[88:89], v200 offset:8192
  ds_read_b64_tr_b16 v[90:91], v200 offset:8704
  ds_read_b64_tr_b16 v[92:93], v200 offset:12288
  ds_read_b64_tr_b16 v[94:95], v200 offset:12800
  v_mov_b32 v204, s58
  v_mov_b32 v205, s58
  v_mov_b32 v206, s58
  v_mov_b32 v207, s58
  v_and_b32 v201, 15, v1
  v_cmp_eq_u32 vcc, 0, v201
  v_mov_b32 v201, 0x80000000
  s_lshl3_add_u32 s61, s48, s49
  v_cndmask_b32 v201, v201, v1, vcc
  s_lshl2_add_u32 s62, s61, s50
  s_lshl_b32 s62, s62, 6
  s_add_u32 s62, s62, 18284544
  s_waitcnt lgkmcnt(6)
  v_mfma_f32_16x16x32_bf16 v[208:211], v[80:83], v[204:207], 0
  s_waitcnt lgkmcnt(4)
  v_mfma_f32_16x16x32_bf16 v[208:211], v[84:87], v[204:207], v[208:211]
  s_waitcnt lgkmcnt(2)
  v_mfma_f32_16x16x32_bf16 v[208:211], v[88:91], v[204:207], v[208:211]
  s_waitcnt lgkmcnt(0)
  v_mfma_f32_16x16x32_bf16 v[208:211], v[92:95], v[204:207], v[208:211]
  v_lshrrev_b32 v35, 4, v1
  v_min_u32 v35, 2, v35
  v_add_u32 v35, s73, v35
  v_max_u32 v35, 1, v35
  v_min_u32 v35, 64, v35
  v_and_b32 v36, 15, v1
  v_lshl_add_u32 v36, v35, 5, v36
  v_lshlrev_b32 v36, 2, v36
  v_add_u32 v36, 18153344, v36
  s_waitcnt vmcnt(19)
  s_barrier
  ds_read_b64_tr_b16 v[80:81], v16 offset:0
  ds_read_b64_tr_b16 v[82:83], v16 offset:512
  ds_read_b64_tr_b16 v[84:85], v19 offset:2048
  ds_read_b64_tr_b16 v[86:87], v19 offset:2560
  ds_read_b64_tr_b16 v[88:89], v16 offset:4096
  ds_read_b64_tr_b16 v[90:91], v16 offset:4608
  ds_read_b64_tr_b16 v[92:93], v19 offset:6144
  ds_read_b64_tr_b16 v[94:95], v19 offset:6656
  ds_read_b64_tr_b16 v[96:97], v16 offset:8192
  ds_read_b64_tr_b16 v[98:99], v16 offset:8704
  s_waitcnt lgkmcnt(8)
  v_mfma_f32_32x32x16_bf16 v[168:183], v[80:83], a[0:3], 0
  buffer_load_dwordx4 v9, s[8:11], s59 offen offset:1024 lds
  ds_read_b64_tr_b16 v[100:101], v19 offset:10240
  ds_read_b64_tr_b16 v[102:103], v19 offset:10752
  s_waitcnt lgkmcnt(8)
  v_mfma_f32_32x32x16_bf16 v[168:183], v[84:87], a[4:7], v[168:183]
  buffer_load_dwordx4 v10, s[8:11], s59 offen offset:2048 lds
  buffer_store_dwordx4 v[208:211], v201, s[40:43], s62 offen sc1
  ds_read_b64_tr_b16 v[80:81], v16 offset:12288
  ds_read_b64_tr_b16 v[82:83], v16 offset:12800
  s_waitcnt lgkmcnt(8)
  v_mfma_f32_32x32x16_bf16 v[168:183], v[88:91], a[8:11], v[168:183]
  buffer_load_dwordx4 v11, s[8:11], s59 offen offset:3072 lds
  v_bfe_u32 v39, v1, 2, 2
  v_lshlrev_b32 v39, 5, v39
  ds_read_b64_tr_b16 v[84:85], v19 offset:14336
  ds_read_b64_tr_b16 v[86:87], v19 offset:14848
  s_waitcnt lgkmcnt(8)
  v_mfma_f32_32x32x16_bf16 v[168:183], v[92:95], a[12:15], v[168:183]
  s_add_u32 s59, s54, 788480
  s_add_u32 m0, s51, 49152
  s_nop 0
  buffer_load_dwordx4 v8, s[8:11], s59 offen offset:0 lds
  v_lshl_add_u32 v39, v38, 3, v39
  v_and_b32 v220, 3, v1
  s_waitcnt vmcnt(20)
  s_barrier
  ds_read_b64_tr_b16 v[88:89], v17 offset:0
  ds_read_b64_tr_b16 v[90:91], v17 offset:512
  s_waitcnt lgkmcnt(8)
  v_mfma_f32_32x32x16_bf16 v[168:183], v[96:99], a[16:19], v[168:183]
  buffer_load_dwordx4 v9, s[8:11], s59 offen offset:1024 lds
  v_lshl_add_u32 v39, v220, 3, v39
  s_lshl_b32 s60, s67, 11
  s_add_u32 s60, s60, 147456
  v_add_u32 v39, s60, v39
  ds_read_b64_tr_b16 v[92:93], v20 offset:2048
  ds_read_b64_tr_b16 v[94:95], v20 offset:2560
  s_waitcnt lgkmcnt(8)
  v_mfma_f32_32x32x16_bf16 v[168:183], v[100:103], a[20:23], v[168:183]
  buffer_load_dwordx4 v10, s[8:11], s59 offen offset:2048 lds
  v_and_b32 v220, 16, v1
  v_lshlrev_b32 v220, 5, v220
  ds_read_b64_tr_b16 v[96:97], v17 offset:4096
  ds_read_b64_tr_b16 v[98:99], v17 offset:4608
  s_waitcnt lgkmcnt(8)
  v_mfma_f32_32x32x16_bf16 v[168:183], v[80:83], a[24:27], v[168:183]
  buffer_load_dwordx4 v11, s[8:11], s59 offen offset:3072 lds
  v_xor_b32 v40, 512, v220
  v_add_u32 v40, v39, v40
  ds_read_b64_tr_b16 v[100:101], v20 offset:6144
  ds_read_b64_tr_b16 v[102:103], v20 offset:6656
  s_waitcnt lgkmcnt(8)
  v_mfma_f32_32x32x16_bf16 v[168:183], v[84:87], a[28:31], v[168:183]
  s_add_u32 s59, s54, 1181696
  s_add_u32 m0, s51, 114688
  s_nop 0
  buffer_load_dwordx4 v8, s[8:11], s59 offen offset:0 lds
  v_add_u32 v39, v39, v220
  v_mov_b32 v222, 0x3f80
  ds_read_b64_tr_b16 v[80:81], v17 offset:8192
  ds_read_b64_tr_b16 v[82:83], v17 offset:8704
  s_waitcnt lgkmcnt(8)
  v_mfma_f32_32x32x16_bf16 v[168:183], v[88:91], a[32:35], v[168:183]
  buffer_load_dwordx4 v9, s[8:11], s59 offen offset:1024 lds
  v_and_b32 v220, 31, v1
  v_lshrrev_b32 v221, 2, v38
  ds_read_b64_tr_b16 v[84:85], v20 offset:10240
  ds_read_b64_tr_b16 v[86:87], v20 offset:10752
  s_waitcnt lgkmcnt(8)
  v_mfma_f32_32x32x16_bf16 v[168:183], v[92:95], a[36:39], v[168:183]
  buffer_load_dwordx4 v10, s[8:11], s59 offen offset:2048 lds
  v_sub_u32 v220, v220, v221
  v_lshlrev_b32 v221, 4, v220
  ds_read_b64_tr_b16 v[88:89], v17 offset:12288
  ds_read_b64_tr_b16 v[90:91], v17 offset:12800
  s_waitcnt lgkmcnt(8)
  v_mfma_f32_32x32x16_bf16 v[168:183], v[96:99], a[40:43], v[168:183]
  buffer_load_dwordx4 v11, s[8:11], s59 offen offset:3072 lds
  s_add_u32 s60, s2, 18153472
  s_waitcnt vmcnt(12)
  buffer_store_dword v3, v34, s[40:43], s60 offen sc1
  v_and_b32 v221, 16, v221
  v_lshlrev_b32 v221, v221, v222
  ds_read_b64_tr_b16 v[92:93], v20 offset:14336
  ds_read_b64_tr_b16 v[94:95], v20 offset:14848
  s_waitcnt lgkmcnt(8)
  v_mfma_f32_32x32x16_bf16 v[168:183], v[100:103], a[44:47], v[168:183]
  s_add_u32 s59, s53, 0
  s_add_u32 m0, s51, 131072
  s_nop 0
  buffer_load_dwordx4 v4, s[24:27], s59 offen offset:0 lds
  v_lshrrev_b32 v220, 1, v220
  v_cmp_eq_u32 vcc, 0, v220
  s_waitcnt vmcnt(11)
  s_barrier
  ds_read_b64_tr_b16 v[96:97], v16 offset:16384
  ds_read_b64_tr_b16 v[98:99], v16 offset:16896
  s_waitcnt lgkmcnt(8)
  v_mfma_f32_32x32x16_bf16 v[168:183], v[80:83], a[48:51], v[168:183]
  buffer_load_dwordx4 v5, s[24:27], s59 offen offset:1024 lds
  v_cmp_eq_u32 s[74:75], 1, v220
  v_cndmask_b32 v152, 0, v221, vcc
  ds_read_b64_tr_b16 v[100:101], v19 offset:18432
  ds_read_b64_tr_b16 v[102:103], v19 offset:18944
  s_waitcnt lgkmcnt(8)
  v_mfma_f32_32x32x16_bf16 v[168:183], v[84:87], a[52:55], v[168:183]
  buffer_load_dwordx4 v6, s[24:27], s59 offen offset:2048 lds
  s_lshl3_add_u32 s60, s48, s49
  s_and_b32 s61, s60, 3
  s_lshr_b32 s60, s60, 2
  s_lshl_b32 s60, s60, 5
  s_add_u32 s60, s60, s61
  s_lshl_b32 s60, s60, 2
  s_add_u32 s60, s60, 18206720
  s_cmp_eq_u32 s50, 0
  s_cbranch_scc0 L_w0_2
  buffer_store_dword v3, v34, s[40:43], s60 offen sc1
L_w0_2:
  v_cndmask_b32 v153, 0, v221, s[74:75]
  v_cmp_eq_u32 vcc, 4, v220
  ds_read_b64_tr_b16 v[80:81], v16 offset:20480
  ds_read_b64_tr_b16 v[82:83], v16 offset:20992
  s_waitcnt lgkmcnt(8)
  v_mfma_f32_32x32x16_bf16 v[168:183], v[88:91], a[56:59], v[168:183]
  buffer_load_dwordx4 v7, s[24:27], s59 offen offset:3072 lds
  v_cmp_eq_u32 s[74:75], 5, v220
  v_cndmask_b32 v154, 0, v221, vcc
  ds_read_b64_tr_b16 v[84:85], v19 offset:22528
  ds_read_b64_tr_b16 v[86:87], v19 offset:23040
  s_waitcnt lgkmcnt(8)
  v_mfma_f32_32x32x16_bf16 v[168:183], v[92:95], a[60:63], v[168:183]
  s_add_u32 s59, s53, 131072
  s_add_u32 m0, s51, 0
  s_nop 0
  buffer_load_dwordx4 v4, s[24:27], s59 offen offset:0 lds
  v_cndmask_b32 v155, 0, v221, s[74:75]
  v_cmp_eq_u32 vcc, 8, v220
  ds_read_b64_tr_b16 v[88:89], v16 offset:24576
  ds_read_b64_tr_b16 v[90:91], v16 offset:25088
  s_waitcnt lgkmcnt(8)
  v_mfma_f32_32x32x16_bf16 v[168:183], v[96:99], a[64:67], v[168:183]
  buffer_load_dwordx4 v5, s[24:27], s59 offen offset:1024 lds
  v_cmp_eq_u32 s[74:75], 9, v220
  v_cndmask_b32 v156, 0, v221, vcc
  ds_read_b64_tr_b16 v[92:93], v19 offset:26624
  ds_read_b64_tr_b16 v[94:95], v19 offset:27136
  s_waitcnt lgkmcnt(8)
  v_mfma_f32_32x32x16_bf16 v[168:183], v[100:103], a[68:71], v[168:183]
  buffer_load_dwordx4 v6, s[24:27], s59 offen offset:2048 lds
  v_cndmask_b32 v157, 0, v221, s[74:75]
  v_cmp_eq_u32 vcc, 12, v220
  ds_read_b64_tr_b16 v[96:97], v16 offset:28672
  ds_read_b64_tr_b16 v[98:99], v16 offset:29184
  s_waitcnt lgkmcnt(8)
  v_mfma_f32_32x32x16_bf16 v[168:183], v[80:83], a[72:75], v[168:183]
  buffer_load_dwordx4 v7, s[24:27], s59 offen offset:3072 lds
  v_cmp_eq_u32 s[74:75], 13, v220
  v_cndmask_b32 v158, 0, v221, vcc
  ds_read_b64_tr_b16 v[100:101], v19 offset:30720
  ds_read_b64_tr_b16 v[102:103], v19 offset:31232
  s_waitcnt lgkmcnt(8)
  v_mfma_f32_32x32x16_bf16 v[168:183], v[84:87], a[76:79], v[168:183]
  v_cndmask_b32 v159, 0, v221, s[74:75]
  s_barrier
  ds_read_b64_tr_b16 v[80:81], v17 offset:16384
  ds_read_b64_tr_b16 v[82:83], v17 offset:16896
  s_waitcnt lgkmcnt(8)
  v_mfma_f32_32x32x16_bf16 v[168:183], v[88:91], a[80:83], v[168:183]
  s_add_u32 s59, s53, 262144
  s_add_u32 m0, s51, 65536
  s_nop 0
  buffer_load_dwordx4 v4, s[24:27], s59 offen offset:0 lds
  ds_read_b64_tr_b16 v[84:85], v20 offset:18432
  ds_read_b64_tr_b16 v[86:87], v20 offset:18944
  s_waitcnt lgkmcnt(8)
  v_mfma_f32_32x32x16_bf16 v[168:183], v[92:95], a[84:87], v[168:183]
  buffer_load_dwordx4 v5, s[24:27], s59 offen offset:1024 lds
  ds_read_b64_tr_b16 v[88:89], v17 offset:20480
  ds_read_b64_tr_b16 v[90:91], v17 offset:20992
  s_waitcnt lgkmcnt(8)
  v_mfma_f32_32x32x16_bf16 v[168:183], v[96:99], a[88:91], v[168:183]
  buffer_load_dwordx4 v6, s[24:27], s59 offen offset:2048 lds
  ds_read_b64_tr_b16 v[92:93], v20 offset:22528
  ds_read_b64_tr_b16 v[94:95], v20 offset:23040
  s_waitcnt lgkmcnt(8)
  v_mfma_f32_32x32x16_bf16 v[168:183], v[100:103], a[92:95], v[168:183]
  buffer_load_dwordx4 v7, s[24:27], s59 offen offset:3072 lds
  ds_read_b64_tr_b16 v[96:97], v17 offset:24576
  ds_read_b64_tr_b16 v[98:99], v17 offset:25088
  s_waitcnt lgkmcnt(8)
  v_mfma_f32_32x32x16_bf16 v[168:183], v[80:83], a[96:99], v[168:183]
  ds_read_b64_tr_b16 v[100:101], v20 offset:26624
  ds_read_b64_tr_b16 v[102:103], v20 offset:27136
  s_waitcnt lgkmcnt(8)
  v_mfma_f32_32x32x16_bf16 v[168:183], v[84:87], a[100:103], v[168:183]
  ds_read_b64_tr_b16 v[80:81], v17 offset:28672
  ds_read_b64_tr_b16 v[82:83], v17 offset:29184
  s_waitcnt lgkmcnt(8)
  v_mfma_f32_32x32x16_bf16 v[168:183], v[88:91], a[104:107], v[168:183]
  ds_read_b64_tr_b16 v[84:85], v20 offset:30720
  ds_read_b64_tr_b16 v[86:87], v20 offset:31232
  s_waitcnt lgkmcnt(8)
  v_mfma_f32_32x32x16_bf16 v[168:183], v[92:95], a[108:111], v[168:183]
  s_waitcnt lgkmcnt(6)
  v_mfma_f32_32x32x16_bf16 v[168:183], v[96:99], a[112:115], v[168:183]
  s_waitcnt lgkmcnt(4)
  v_mfma_f32_32x32x16_bf16 v[168:183], v[100:103], a[116:119], v[168:183]
  s_waitcnt lgkmcnt(2)
  v_mfma_f32_32x32x16_bf16 v[168:183], v[80:83], a[120:123], v[168:183]
  s_waitcnt lgkmcnt(0)
  v_mfma_f32_32x32x16_bf16 v[168:183], v[84:87], a[124:127], v[168:183]
  s_barrier
  ds_read_b64_tr_b16 v[80:81], v16 offset:32768
  ds_read_b64_tr_b16 v[82:83], v16 offset:33280
  ds_read_b64_tr_b16 v[84:85], v19 offset:34816
  ds_read_b64_tr_b16 v[86:87], v19 offset:35328
  ds_read_b64_tr_b16 v[88:89], v16 offset:36864
  ds_read_b64_tr_b16 v[90:91], v16 offset:37376
  ds_read_b64_tr_b16 v[92:93], v19 offset:38912
  ds_read_b64_tr_b16 v[94:95], v19 offset:39424
  ds_read_b64_tr_b16 v[96:97], v16 offset:40960
  ds_read_b64_tr_b16 v[98:99], v16 offset:41472
  s_waitcnt lgkmcnt(8)
  v_mfma_f32_32x32x16_bf16 v[184:199], a[0:3], v[80:83], 0
  ds_read_b64_tr_b16 v[100:101], v19 offset:43008
  ds_read_b64_tr_b16 v[102:103], v19 offset:43520
  s_waitcnt lgkmcnt(8)
  v_mfma_f32_32x32x16_bf16 v[184:199], a[4:7], v[84:87], v[184:199]
  s_add_u32 s59, s53, 393216
  s_add_u32 m0, s51, 16384
  s_nop 0
  buffer_load_dwordx4 v4, s[24:27], s59 offen offset:0 lds
  ds_read_b64_tr_b16 v[80:81], v16 offset:45056
  ds_read_b64_tr_b16 v[82:83], v16 offset:45568
  s_waitcnt lgkmcnt(8)
  v_mfma_f32_32x32x16_bf16 v[184:199], a[8:11], v[88:91], v[184:199]
  ds_read_b64_tr_b16 v[160:161], v39 offset:0
  ds_read_b64_tr_b16 v[162:163], v39 offset:256
  ds_read_b64_tr_b16 v[84:85], v19 offset:47104
  ds_read_b64_tr_b16 v[86:87], v19 offset:47616
  s_waitcnt lgkmcnt(10)
  v_mfma_f32_32x32x16_bf16 v[184:199], a[12:15], v[92:95], v[184:199]
  buffer_load_dwordx4 v5, s[24:27], s59 offen offset:1024 lds
  ds_read_b64_tr_b16 v[164:165], v40 offset:1024
  ds_read_b64_tr_b16 v[166:167], v40 offset:1280
  s_waitcnt vmcnt(23)
  s_barrier
  ds_read_b64_tr_b16 v[88:89], v17 offset:32768
  ds_read_b64_tr_b16 v[90:91], v17 offset:33280
  s_waitcnt lgkmcnt(12)
  v_mfma_f32_32x32x16_bf16 v[184:199], a[16:19], v[96:99], v[184:199]
  ds_read_b64_tr_b16 v[92:93], v20 offset:34816
  ds_read_b64_tr_b16 v[94:95], v20 offset:35328
  s_waitcnt lgkmcnt(12)
  v_mfma_f32_32x32x16_bf16 v[184:199], a[20:23], v[100:103], v[184:199]
  buffer_load_dwordx4 v6, s[24:27], s59 offen offset:2048 lds
  ds_read_b64_tr_b16 v[96:97], v17 offset:36864
  ds_read_b64_tr_b16 v[98:99], v17 offset:37376
  s_waitcnt lgkmcnt(12)
  v_mfma_f32_32x32x16_bf16 v[184:199], a[24:27], v[80:83], v[184:199]
  ds_read_b64_tr_b16 v[100:101], v20 offset:38912
  ds_read_b64_tr_b16 v[102:103], v20 offset:39424
  s_waitcnt lgkmcnt(10)
  v_mfma_f32_32x32x16_bf16 v[184:199], a[28:31], v[84:87], v[184:199]
  buffer_load_dwordx4 v7, s[24:27], s59 offen offset:3072 lds
  ds_read_b64_tr_b16 v[80:81], v17 offset:40960
  ds_read_b64_tr_b16 v[82:83], v17 offset:41472
  s_waitcnt lgkmcnt(8)
  v_mfma_f32_32x32x16_bf16 v[184:199], a[32:35], v[88:91], v[184:199]
  ds_read_b64_tr_b16 v[84:85], v20 offset:43008
  ds_read_b64_tr_b16 v[86:87], v20 offset:43520
  s_waitcnt lgkmcnt(8)
  v_mfma_f32_32x32x16_bf16 v[184:199], a[36:39], v[92:95], v[184:199]
  s_add_u32 s59, s54, 0
  s_add_u32 m0, s51, 81920
  s_nop 0
  buffer_load_dwordx4 v8, s[8:11], s59 offen offset:0 lds
  ds_read_b64_tr_b16 v[88:89], v17 offset:45056
  ds_read_b64_tr_b16 v[90:91], v17 offset:45568
  s_waitcnt lgkmcnt(8)
  v_mfma_f32_32x32x16_bf16 v[184:199], a[40:43], v[96:99], v[184:199]
  ds_read_b64_tr_b16 v[92:93], v20 offset:47104
  ds_read_b64_tr_b16 v[94:95], v20 offset:47616
  s_waitcnt lgkmcnt(8)
  v_mfma_f32_32x32x16_bf16 v[184:199], a[44:47], v[100:103], v[184:199]
  buffer_load_dwordx4 v9, s[8:11], s59 offen offset:1024 lds
  s_waitcnt vmcnt(23)
  s_barrier
  ds_read_b64_tr_b16 v[96:97], v16 offset:49152
  ds_read_b64_tr_b16 v[98:99], v16 offset:49664
  s_waitcnt lgkmcnt(8)
  v_mfma_f32_32x32x16_bf16 v[184:199], a[48:51], v[80:83], v[184:199]
  ds_read_b64_tr_b16 v[100:101], v19 offset:51200
  ds_read_b64_tr_b16 v[102:103], v19 offset:51712
  s_waitcnt lgkmcnt(8)
  v_mfma_f32_32x32x16_bf16 v[184:199], a[52:55], v[84:87], v[184:199]
  buffer_load_dwordx4 v10, s[8:11], s59 offen offset:2048 lds
  ds_read_b64_tr_b16 v[80:81], v16 offset:53248
  ds_read_b64_tr_b16 v[82:83], v16 offset:53760
  s_waitcnt lgkmcnt(8)
  v_mfma_f32_32x32x16_bf16 v[184:199], a[56:59], v[88:91], v[184:199]
  ds_read_b64_tr_b16 v[84:85], v19 offset:55296
  ds_read_b64_tr_b16 v[86:87], v19 offset:55808
  s_waitcnt lgkmcnt(8)
  v_mfma_f32_32x32x16_bf16 v[184:199], a[60:63], v[92:95], v[184:199]
  buffer_load_dwordx4 v11, s[8:11], s59 offen offset:3072 lds
  ds_read_b64_tr_b16 v[88:89], v16 offset:57344
  ds_read_b64_tr_b16 v[90:91], v16 offset:57856
  s_waitcnt lgkmcnt(8)
  v_mfma_f32_32x32x16_bf16 v[184:199], a[64:67], v[96:99], v[184:199]
  ds_read_b64_tr_b16 v[92:93], v19 offset:59392
  ds_read_b64_tr_b16 v[94:95], v19 offset:59904
  s_waitcnt lgkmcnt(8)
  v_mfma_f32_32x32x16_bf16 v[184:199], a[68:71], v[100:103], v[184:199]
  s_add_u32 s59, s54, 393216
  s_add_u32 m0, s51, 32768
  s_nop 0
  buffer_load_dwordx4 v8, s[8:11], s59 offen offset:0 lds
  ds_read_b64_tr_b16 v[96:97], v16 offset:61440
  ds_read_b64_tr_b16 v[98:99], v16 offset:61952
  s_waitcnt lgkmcnt(8)
  v_mfma_f32_32x32x16_bf16 v[184:199], a[72:75], v[80:83], v[184:199]
  ds_read_b64_tr_b16 v[100:101], v19 offset:63488
  ds_read_b64_tr_b16 v[102:103], v19 offset:64000
  s_waitcnt lgkmcnt(8)
  v_mfma_f32_32x32x16_bf16 v[184:199], a[76:79], v[84:87], v[184:199]
  buffer_load_dwordx4 v9, s[8:11], s59 offen offset:1024 lds
  s_waitcnt vmcnt(23)
  s_barrier
  ds_read_b64_tr_b16 v[80:81], v17 offset:49152
  ds_read_b64_tr_b16 v[82:83], v17 offset:49664
  s_waitcnt lgkmcnt(8)
  v_mfma_f32_32x32x16_bf16 v[184:199], a[80:83], v[88:91], v[184:199]
  buffer_load_dword v35, v36, s[40:43], 0 offen sc1
  ds_read_b64_tr_b16 v[84:85], v20 offset:51200
  ds_read_b64_tr_b16 v[86:87], v20 offset:51712
  s_waitcnt lgkmcnt(8)
  v_mfma_f32_32x32x16_bf16 v[184:199], a[84:87], v[92:95], v[184:199]
  buffer_load_dwordx4 v10, s[8:11], s59 offen offset:2048 lds
  ds_read_b64_tr_b16 v[88:89], v17 offset:53248
  ds_read_b64_tr_b16 v[90:91], v17 offset:53760
  s_waitcnt lgkmcnt(8)
  v_mfma_f32_32x32x16_bf16 v[184:199], a[88:91], v[96:99], v[184:199]
  ds_read_b64_tr_b16 v[92:93], v20 offset:55296
  ds_read_b64_tr_b16 v[94:95], v20 offset:55808
  s_waitcnt lgkmcnt(8)
  v_mfma_f32_32x32x16_bf16 v[184:199], a[92:95], v[100:103], v[184:199]
  buffer_load_dwordx4 v11, s[8:11], s59 offen offset:3072 lds
  ds_read_b64_tr_b16 v[96:97], v17 offset:57344
  ds_read_b64_tr_b16 v[98:99], v17 offset:57856
  s_waitcnt lgkmcnt(8)
  v_mfma_f32_32x32x16_bf16 v[184:199], a[96:99], v[80:83], v[184:199]
  ds_read_b64_tr_b16 v[100:101], v20 offset:59392
  ds_read_b64_tr_b16 v[102:103], v20 offset:59904
  s_waitcnt lgkmcnt(8)
  v_mfma_f32_32x32x16_bf16 v[184:199], a[100:103], v[84:87], v[184:199]
  s_add_u32 s59, s54, 786432
  s_add_u32 m0, s51, 98304
  s_nop 0
  buffer_load_dwordx4 v8, s[8:11], s59 offen offset:0 lds
  ds_read_b64_tr_b16 v[80:81], v17 offset:61440
  ds_read_b64_tr_b16 v[82:83], v17 offset:61952
  s_waitcnt lgkmcnt(8)
  v_mfma_f32_32x32x16_bf16 v[184:199], a[104:107], v[88:91], v[184:199]
  ds_read_b64_tr_b16 v[84:85], v20 offset:63488
  ds_read_b64_tr_b16 v[86:87], v20 offset:64000
  s_waitcnt lgkmcnt(8)
  v_mfma_f32_32x32x16_bf16 v[184:199], a[108:111], v[92:95], v[184:199]
  buffer_load_dwordx4 v9, s[8:11], s59 offen offset:1024 lds
  s_waitcnt lgkmcnt(6)
  v_mfma_f32_32x32x16_bf16 v[184:199], a[112:115], v[96:99], v[184:199]
  s_waitcnt lgkmcnt(4)
  v_mfma_f32_32x32x16_bf16 v[184:199], a[116:119], v[100:103], v[184:199]
  buffer_load_dwordx4 v10, s[8:11], s59 offen offset:2048 lds
  s_waitcnt lgkmcnt(2)
  v_mfma_f32_32x32x16_bf16 v[184:199], a[120:123], v[80:83], v[184:199]
  s_waitcnt lgkmcnt(0)
  v_mfma_f32_32x32x16_bf16 v[184:199], a[124:127], v[84:87], v[184:199]
  buffer_load_dwordx4 v11, s[8:11], s59 offen offset:3072 lds
  s_waitcnt vmcnt(6)
  v_cmp_ne_u32 vcc, v3, v35
  s_nop 0
  s_cbranch_vccz L_ok_3
  s_mov_b32 s63, 200000
L_spin_4:
  buffer_load_dword v35, v36, s[40:43], 0 offen sc1
  s_waitcnt vmcnt(0)
  v_cmp_ne_u32 vcc, v3, v35
  s_nop 0
  s_cbranch_vccz L_ok_3
  s_sub_u32 s63, s63, 1
  s_cbranch_scc0 L_spin_4
L_ok_3:
  s_lshl3_add_u32 s71, s73, s67
  s_lshl_b32 s71, s71, 12
  buffer_load_dwordx4 a[128:131], v2, s[40:43], s71 offen offset:0 sc1
  buffer_load_dwordx4 a[132:135], v2, s[40:43], s71 offen offset:1024 sc1
  buffer_load_dwordx4 a[136:139], v2, s[40:43], s71 offen offset:2048 sc1
  buffer_load_dwordx4 a[140:143], v2, s[40:43], s71 offen offset:3072 sc1
  s_add_u32 s71, s71, 8192
  buffer_load_dwordx4 a[144:147], v2, s[40:43], s71 offen offset:0 sc1
  buffer_load_dwordx4 a[148:151], v2, s[40:43], s71 offen offset:1024 sc1
  buffer_load_dwordx4 a[152:155], v2, s[40:43], s71 offen offset:2048 sc1
  buffer_load_dwordx4 a[156:159], v2, s[40:43], s71 offen offset:3072 sc1
  s_add_u32 s71, s71, 8192
  buffer_load_dwordx4 a[160:163], v2, s[40:43], s71 offen offset:0 sc1
  buffer_load_dwordx4 a[164:167], v2, s[40:43], s71 offen offset:1024 sc1
  s_min_u32 s60, s65, 13
  s_lshl_b32 s60, s60, 1
  s_add_u32 s60, s60, 24
  v_min_u32 v36, 19, v1
  v_lshrrev_b32 v35, 2, v36
  v_cmp_gt_u32 vcc, 3, v35
  v_lshl_add_u32 v250, v35, 3, s49
  v_add_u32 v35, s60, v35
  v_subrev_u32 v35, 3, v35
  v_cndmask_b32 v35, v35, v250, vcc
  v_and_b32 v36, 3, v36
  v_lshl_add_u32 v36, v35, 5, v36
  v_lshlrev_b32 v36, 2, v36
  v_add_u32 v36, 18206720, v36
  buffer_load_dword v35, v36, s[40:43], 0 offen sc1
  v_mul_f32 v200, v42, v44
  s_barrier
  ds_read_b64_tr_b16 v[80:81], v30 offset:0
  ds_read_b64_tr_b16 v[82:83], v30 offset:1024
  ds_read_b64_tr_b16 v[84:85], v33 offset:0
  ds_read_b64_tr_b16 v[86:87], v33 offset:1024
  ds_read_b64_tr_b16 v[88:89], v30 offset:2048
  ds_read_b64_tr_b16 v[90:91], v30 offset:3072
  ds_read_b64_tr_b16 v[92:93], v33 offset:2048
  ds_read_b64_tr_b16 v[94:95], v33 offset:3072
  ds_read_b64_tr_b16 v[96:97], v30 offset:4096
  ds_read_b64_tr_b16 v[98:99], v30 offset:5120
  s_waitcnt vmcnt(10) lgkmcnt(8)
  v_mfma_f32_32x32x16_bf16 v[104:119], v[80:83], a[128:131], 0
  buffer_load_dwordx4 a[168:171], v2, s[40:43], s71 offen offset:2048 sc1
  ds_read_b64_tr_b16 v[100:101], v33 offset:4096
  ds_read_b64_tr_b16 v[102:103], v33 offset:5120
  s_waitcnt lgkmcnt(8)
  v_mfma_f32_32x32x16_bf16 v[120:135], v[84:87], a[128:131], 0
  ds_read_b64_tr_b16 v[80:81], v30 offset:6144
  ds_read_b64_tr_b16 v[82:83], v30 offset:7168
  s_waitcnt vmcnt(10) lgkmcnt(8)
  v_mfma_f32_32x32x16_bf16 v[104:119], v[88:91], a[132:135], v[104:119]
  buffer_load_dwordx4 a[172:175], v2, s[40:43], s71 offen offset:3072 sc1
  ds_read_b64_tr_b16 v[84:85], v33 offset:6144
  ds_read_b64_tr_b16 v[86:87], v33 offset:7168
  s_waitcnt lgkmcnt(8)
  v_mfma_f32_32x32x16_bf16 v[120:135], v[92:95], a[132:135], v[120:135]
  s_barrier
  ds_read_b64_tr_b16 v[88:89], v28 offset:0
  ds_read_b64_tr_b16 v[90:91], v28 offset:1024
  s_waitcnt vmcnt(10) lgkmcnt(8)
  v_mfma_f32_32x32x16_bf16 v[104:119], v[96:99], a[136:139], v[104:119]
  s_add_u32 s71, s71, 8192
  buffer_load_dwordx4 a[176:179], v2, s[40:43], s71 offen offset:0 sc1
  ds_read_b64_tr_b16 v[92:93], v31 offset:0
  ds_read_b64_tr_b16 v[94:95], v31 offset:1024
  s_waitcnt lgkmcnt(8)
  v_mfma_f32_32x32x16_bf16 v[120:135], v[100:103], a[136:139], v[120:135]
  ds_read_b64_tr_b16 v[96:97], v28 offset:2048
  ds_read_b64_tr_b16 v[98:99], v28 offset:3072
  s_waitcnt vmcnt(10) lgkmcnt(8)
  v_mfma_f32_32x32x16_bf16 v[104:119], v[80:83], a[140:143], v[104:119]
  buffer_load_dwordx4 a[180:183], v2, s[40:43], s71 offen offset:1024 sc1
  ds_read_b64_tr_b16 v[100:101], v31 offset:2048
  ds_read_b64_tr_b16 v[102:103], v31 offset:3072
  s_waitcnt lgkmcnt(8)
  v_mfma_f32_32x32x16_bf16 v[120:135], v[84:87], a[140:143], v[120:135]
  ds_read_b64_tr_b16 v[80:81], v28 offset:4096
  ds_read_b64_tr_b16 v[82:83], v28 offset:5120
  s_waitcnt vmcnt(10) lgkmcnt(8)
  v_mfma_f32_32x32x16_bf16 v[104:119], v[88:91], a[144:147], v[104:119]
  buffer_load_dwordx4 a[184:187], v2, s[40:43], s71 offen offset:2048 sc1
  ds_read_b64_tr_b16 v[84:85], v31 offset:4096
  ds_read_b64_tr_b16 v[86:87], v31 offset:5120
  s_waitcnt lgkmcnt(8)
  v_mfma_f32_32x32x16_bf16 v[120:135], v[92:95], a[144:147], v[120:135]
  ds_read_b64_tr_b16 v[88:89], v28 offset:6144
  ds_read_b64_tr_b16 v[90:91], v28 offset:7168
  s_waitcnt vmcnt(10) lgkmcnt(8)
  v_mfma_f32_32x32x16_bf16 v[104:119], v[96:99], a[148:151], v[104:119]
  buffer_load_dwordx4 a[188:191], v2, s[40:43], s71 offen offset:3072 sc1
  ds_read_b64_tr_b16 v[92:93], v31 offset:6144
  ds_read_b64_tr_b16 v[94:95], v31 offset:7168
  s_waitcnt lgkmcnt(8)
  v_mfma_f32_32x32x16_bf16 v[120:135], v[100:103], a[148:151], v[120:135]
  s_waitcnt vmcnt(6)
  v_cmp_ne_u32 vcc, v3, v35
  s_nop 0
  s_cbranch_vccz L_ok_5
  s_mov_b32 s63, 200000
L_spin_6:
  buffer_load_dword v35, v36, s[40:43], 0 offen sc1
  s_waitcnt vmcnt(0)
  v_cmp_ne_u32 vcc, v3, v35
  s_nop 0
  s_cbranch_vccz L_ok_5
  s_sub_u32 s63, s63, 1
  s_cbranch_scc0 L_spin_6
L_ok_5:
  s_min_u32 s60, s65, 13
  s_lshl1_add_u32 s60, s60, 24
  s_lshl3_add_u32 s61, s50, s49
  s_cmp_eq_u32 s50, 3
  s_cselect_b32 s61, s60, s61
  s_lshl_b32 s61, s61, 10
  s_add_u32 s61, s61, 18284544
  s_lshl_b32 s62, s50, 10
  s_add_u32 m0, s62, 153600
  s_lshl_b32 s60, s60, 10
  buffer_load_dwordx4 v2, s[40:43], s61 offen sc1 lds
  s_add_u32 s60, s60, 18285568
  s_mov_b32 m0, 157696
  s_cmp_eq_u32 s50, 0
  s_cbranch_scc0 L_cs_7
  buffer_load_dwordx4 v2, s[40:43], s60 offen sc1 lds
L_cs_7:
  s_barrier
  ds_read_b64_tr_b16 v[96:97], v29 offset:0
  ds_read_b64_tr_b16 v[98:99], v29 offset:1024
  s_waitcnt lgkmcnt(8)
  v_mfma_f32_32x32x16_bf16 v[104:119], v[80:83], a[152:155], v[104:119]
  ds_read_b64_tr_b16 v[100:101], v32 offset:0
  ds_read_b64_tr_b16 v[102:103], v32 offset:1024
  s_waitcnt lgkmcnt(8)
  v_mfma_f32_32x32x16_bf16 v[120:135], v[84:87], a[152:155], v[120:135]
  ds_read_b64_tr_b16 v[80:81], v29 offset:2048
  ds_read_b64_tr_b16 v[82:83], v29 offset:3072
  s_waitcnt lgkmcnt(8)
  v_mfma_f32_32x32x16_bf16 v[104:119], v[88:91], a[156:159], v[104:119]
  ds_read_b64_tr_b16 v[84:85], v32 offset:2048
  ds_read_b64_tr_b16 v[86:87], v32 offset:3072
  s_waitcnt lgkmcnt(8)
  v_mfma_f32_32x32x16_bf16 v[120:135], v[92:95], a[156:159], v[120:135]
  ds_read_b64_tr_b16 v[88:89], v29 offset:4096
  ds_read_b64_tr_b16 v[90:91], v29 offset:5120
  s_waitcnt lgkmcnt(8)
  v_mfma_f32_32x32x16_bf16 v[104:119], v[96:99], a[160:163], v[104:119]
  s_add_u32 s59, s54, 1179648
  s_add_u32 m0, s51, 49152
  s_nop 0
  buffer_load_dwordx4 v8, s[8:11], s59 offen offset:0 lds
  ds_read_b64_tr_b16 v[92:93], v32 offset:4096
  ds_read_b64_tr_b16 v[94:95], v32 offset:5120
  s_waitcnt lgkmcnt(8)
  v_mfma_f32_32x32x16_bf16 v[120:135], v[100:103], a[160:163], v[120:135]
  ds_read_b64_tr_b16 v[96:97], v29 offset:6144
  ds_read_b64_tr_b16 v[98:99], v29 offset:7168
  s_waitcnt lgkmcnt(8)
  v_mfma_f32_32x32x16_bf16 v[104:119], v[80:83], a[164:167], v[104:119]
  buffer_load_dwordx4 v9, s[8:11], s59 offen offset:1024 lds
  ds_read_b64_tr_b16 v[100:101], v32 offset:6144
  ds_read_b64_tr_b16 v[102:103], v32 offset:7168
  s_waitcnt lgkmcnt(8)
  v_mfma_f32_32x32x16_bf16 v[120:135], v[84:87], a[164:167], v[120:135]
  s_barrier
  ds_read_b64_tr_b16 v[80:81], v28 offset:16384
  ds_read_b64_tr_b16 v[82:83], v28 offset:17408
  s_waitcnt vmcnt(8) lgkmcnt(8)
  v_mfma_f32_32x32x16_bf16 v[104:119], v[88:91], a[168:171], v[104:119]
  buffer_load_dwordx4 v10, s[8:11], s59 offen offset:2048 lds
  ds_read_b64_tr_b16 v[84:85], v31 offset:16384
  ds_read_b64_tr_b16 v[86:87], v31 offset:17408
  s_waitcnt lgkmcnt(8)
  v_mfma_f32_32x32x16_bf16 v[120:135], v[92:95], a[168:171], v[120:135]
  ds_read_b64_tr_b16 v[88:89], v28 offset:18432
  ds_read_b64_tr_b16 v[90:91], v28 offset:19456
  s_waitcnt vmcnt(8) lgkmcnt(8)
  v_mfma_f32_32x32x16_bf16 v[104:119], v[96:99], a[172:175], v[104:119]
  buffer_load_dwordx4 v11, s[8:11], s59 offen offset:3072 lds
  ds_read_b64_tr_b16 v[92:93], v31 offset:18432
  ds_read_b64_tr_b16 v[94:95], v31 offset:19456
  s_waitcnt lgkmcnt(8)
  v_mfma_f32_32x32x16_bf16 v[120:135], v[100:103], a[172:175], v[120:135]
  ds_read_b64_tr_b16 v[96:97], v28 offset:20480
  ds_read_b64_tr_b16 v[98:99], v28 offset:21504
  s_waitcnt vmcnt(8) lgkmcnt(8)
  v_mfma_f32_32x32x16_bf16 v[104:119], v[80:83], a[176:179], v[104:119]
  s_add_u32 s59, s55, 0
  s_add_u32 m0, s51, 114688
  s_nop 0
  buffer_load_dwordx4 v12, s[28:31], s59 offen offset:0 lds
  ds_read_b64_tr_b16 v[100:101], v31 offset:20480
  ds_read_b64_tr_b16 v[102:103], v31 offset:21504
  s_waitcnt lgkmcnt(8)
  v_mfma_f32_32x32x16_bf16 v[120:135], v[84:87], a[176:179], v[120:135]
  ds_read_b64_tr_b16 v[80:81], v28 offset:22528
  ds_read_b64_tr_b16 v[82:83], v28 offset:23552
  s_waitcnt vmcnt(8) lgkmcnt(8)
  v_mfma_f32_32x32x16_bf16 v[104:119], v[88:91], a[180:183], v[104:119]
  buffer_load_dwordx4 v13, s[28:31], s59 offen offset:1024 lds
  ds_read_b64_tr_b16 v[84:85], v31 offset:22528
  ds_read_b64_tr_b16 v[86:87], v31 offset:23552
  s_waitcnt lgkmcnt(8)
  v_mfma_f32_32x32x16_bf16 v[120:135], v[92:95], a[180:183], v[120:135]
  s_waitcnt vmcnt(6)
  s_lshl_b32 s60, s50, 10
  s_add_u32 s60, s60, 153600
  v_lshl_add_u32 v240, v1, 2, s60
  v_lshlrev_b32 v241, 2, v1
  v_add_u32 v241, 157696, v241
  ds_read2st64_b32 v[242:243], v240 offset0:0 offset1:1
  ds_read2st64_b32 v[244:245], v240 offset0:2 offset1:3
  ds_read2st64_b32 v[246:247], v241 offset0:0 offset1:1
  ds_read2st64_b32 v[248:249], v241 offset0:2 offset1:3
  s_mul_i32 s60, s50, -768
  s_add_u32 s60, s60, 5120
  v_add_u32 v240, s60, v240
  s_waitcnt lgkmcnt(10)
  v_mfma_f32_32x32x16_bf16 v[104:119], v[96:99], a[184:187], v[104:119]
  buffer_load_dwordx4 v14, s[28:31], s59 offen offset:2048 lds
  s_waitcnt lgkmcnt(8)
  v_mfma_f32_32x32x16_bf16 v[120:135], v[100:103], a[184:187], v[120:135]
  s_waitcnt lgkmcnt(6)
  v_mfma_f32_32x32x16_bf16 v[104:119], v[80:83], a[188:191], v[104:119]
  s_waitcnt lgkmcnt(3)
  v_add_f32 v242, v242, v243
  s_waitcnt lgkmcnt(2)
  v_add_f32 v244, v244, v245
  s_waitcnt lgkmcnt(1)
  v_add_f32 v246, v246, v247
  s_waitcnt lgkmcnt(0)
  v_add_f32 v248, v248, v249
  v_add_f32 v242, v242, v244
  v_add_f32 v246, v246, v248
  ds_write_b32 v240, v242
  s_cmp_eq_u32 s50, 0
  s_cbranch_scc0 L_w0_8
  ds_write_b32 v241, v246 offset:2048
L_w0_8:
  buffer_load_dwordx4 v15, s[28:31], s59 offen offset:3072 lds
  v_mfma_f32_32x32x16_bf16 v[120:135], v[84:87], a[188:191], v[120:135]
  v_add_u32 v202, s51, v2
  v_add_u32 v202, 131072, v202
  v_xor_b32 v203, 4096, v202
  s_nop 8
  ds_write_b128 v202, v[120:123] offset:0
  ds_write_b128 v202, v[124:127] offset:1024
  ds_write_b128 v202, v[128:131] offset:2048
  ds_write_b128 v202, v[132:135] offset:3072
  v_lshlrev_b32 v204, 16, v52
  v_and_b32 v205, 0xffff0000, v52
  v_pk_add_f32 v[104:105], v[104:105], v[200:201] op_sel_hi:[1,0]
  v_pk_fma_f32 v[104:105], v[204:205], v[44:45], v[104:105] op_sel_hi:[1,0,1]
  v_lshlrev_b32 v206, 16, v53
  v_and_b32 v207, 0xffff0000, v53
  v_pk_add_f32 v[106:107], v[106:107], v[200:201] op_sel_hi:[1,0]
  v_pk_fma_f32 v[106:107], v[206:207], v[44:45], v[106:107] op_sel_hi:[1,0,1]
  v_lshlrev_b32 v208, 16, v54
  v_and_b32 v209, 0xffff0000, v54
  v_pk_add_f32 v[108:109], v[108:109], v[200:201] op_sel_hi:[1,0]
  v_pk_fma_f32 v[108:109], v[208:209], v[44:45], v[108:109] op_sel_hi:[1,0,1]
  v_lshlrev_b32 v210, 16, v55
  v_and_b32 v211, 0xffff0000, v55
  v_pk_add_f32 v[110:111], v[110:111], v[200:201] op_sel_hi:[1,0]
  v_pk_fma_f32 v[110:111], v[210:211], v[44:45], v[110:111] op_sel_hi:[1,0,1]
  v_lshlrev_b32 v204, 16, v56
  v_and_b32 v205, 0xffff0000, v56
  v_pk_add_f32 v[112:113], v[112:113], v[200:201] op_sel_hi:[1,0]
  v_pk_fma_f32 v[112:113], v[204:205], v[44:45], v[112:113] op_sel_hi:[1,0,1]
  v_lshlrev_b32 v206, 16, v57
  v_and_b32 v207, 0xffff0000, v57
  v_pk_add_f32 v[114:115], v[114:115], v[200:201] op_sel_hi:[1,0]
  v_pk_fma_f32 v[114:115], v[206:207], v[44:45], v[114:115] op_sel_hi:[1,0,1]
  v_lshlrev_b32 v208, 16, v58
  v_and_b32 v209, 0xffff0000, v58
  v_pk_add_f32 v[116:117], v[116:117], v[200:201] op_sel_hi:[1,0]
  v_pk_fma_f32 v[116:117], v[208:209], v[44:45], v[116:117] op_sel_hi:[1,0,1]
  v_lshlrev_b32 v210, 16, v59
  v_and_b32 v211, 0xffff0000, v59
  v_pk_add_f32 v[118:119], v[118:119], v[200:201] op_sel_hi:[1,0]
  v_pk_fma_f32 v[118:119], v[210:211], v[44:45], v[118:119] op_sel_hi:[1,0,1]
  s_waitcnt lgkmcnt(0)
  s_barrier
  ds_read_b128 v[120:123], v203 offset:0
  ds_read_b128 v[124:127], v203 offset:1024
  ds_read_b128 v[128:131], v203 offset:2048
  ds_read_b128 v[132:135], v203 offset:3072
  s_lshl4_add_u32 s61, s73, s3
  s_lshl_b32 s60, s61, 11
  s_add_u32 s60, s60, 2097152
  v_mov_b32 v68, 0
  v_mov_b32 v69, 0
  v_mov_b32 v70, 0
  v_mov_b32 v71, 0
  s_waitcnt lgkmcnt(3)
  v_pk_add_f32 v[104:105], v[104:105], v[120:121]
  v_cvt_pk_bf16_f32 v60, v104, v105
  v_pk_add_f32 v[106:107], v[106:107], v[122:123]
  v_cvt_pk_bf16_f32 v61, v106, v107
  s_waitcnt lgkmcnt(2)
  v_pk_add_f32 v[108:109], v[108:109], v[124:125]
  v_cvt_pk_bf16_f32 v62, v108, v109
  v_pk_add_f32 v[110:111], v[110:111], v[126:127]
  v_cvt_pk_bf16_f32 v63, v110, v111
  buffer_store_dwordx4 v[60:63], v2, s[40:43], s60 offen offset:0 sc1
  s_waitcnt lgkmcnt(1)
  v_pk_add_f32 v[112:113], v[112:113], v[128:129]
  v_cvt_pk_bf16_f32 v64, v112, v113
  v_pk_add_f32 v[114:115], v[114:115], v[130:131]
  v_cvt_pk_bf16_f32 v65, v114, v115
  s_waitcnt lgkmcnt(0)
  v_pk_add_f32 v[116:117], v[116:117], v[132:133]
  v_cvt_pk_bf16_f32 v66, v116, v117
  v_pk_add_f32 v[118:119], v[118:119], v[134:135]
  v_cvt_pk_bf16_f32 v67, v118, v119
  buffer_store_dwordx4 v[64:67], v2, s[40:43], s60 offen offset:1024 sc1
  v_dot2c_f32_bf16 v68, s58, v60
  v_dot2c_f32_bf16 v70, v60, v60
  v_dot2c_f32_bf16 v69, s58, v61
  v_dot2c_f32_bf16 v71, v61, v61
  v_dot2c_f32_bf16 v68, s58, v62
  v_dot2c_f32_bf16 v70, v62, v62
  v_dot2c_f32_bf16 v69, s58, v63
  v_dot2c_f32_bf16 v71, v63, v63
  v_dot2c_f32_bf16 v68, s58, v64
  v_dot2c_f32_bf16 v70, v64, v64
  v_dot2c_f32_bf16 v69, s58, v65
  v_dot2c_f32_bf16 v71, v65, v65
  v_dot2c_f32_bf16 v68, s58, v66
  v_dot2c_f32_bf16 v70, v66, v66
  v_dot2c_f32_bf16 v69, s58, v67
  v_dot2c_f32_bf16 v71, v67, v67
  s_lshl_b32 s61, s61, 8
  s_add_u32 s61, s61, 17891328
  v_lshlrev_b32 v204, 2, v1
  v_add_f32 v68, v68, v69
  v_add_f32 v70, v70, v71
  s_nop 1
  v_permlane32_swap_b32 v68, v70
  v_add_f32 v68, v68, v70
  buffer_store_dword v68, v204, s[40:43], s61 offen sc1
  s_lshl_b32 s60, s67, 7
  s_add_u32 s60, s60, 158976
  v_add_u32 v232, s60, v38
  ds_read_b128 v[120:123], v232 offset:0
  ds_read_b128 v[124:127], v232 offset:32
  ds_read_b128 v[128:131], v232 offset:64
  ds_read_b128 v[132:135], v232 offset:96
  s_waitcnt lgkmcnt(3)
  v_pk_fma_f32 v[168:169], v[120:121], v[42:43], v[168:169] op_sel_hi:[1,0,1]
  v_pk_fma_f32 v[170:171], v[122:123], v[42:43], v[170:171] op_sel_hi:[1,0,1]
  s_waitcnt lgkmcnt(2)
  v_pk_fma_f32 v[172:173], v[124:125], v[42:43], v[172:173] op_sel_hi:[1,0,1]
  v_pk_fma_f32 v[174:175], v[126:127], v[42:43], v[174:175] op_sel_hi:[1,0,1]
  s_waitcnt lgkmcnt(1)
  v_pk_fma_f32 v[176:177], v[128:129], v[42:43], v[176:177] op_sel_hi:[1,0,1]
  v_pk_fma_f32 v[178:179], v[130:131], v[42:43], v[178:179] op_sel_hi:[1,0,1]
  s_waitcnt lgkmcnt(0)
  v_pk_fma_f32 v[180:181], v[132:133], v[42:43], v[180:181] op_sel_hi:[1,0,1]
  v_pk_fma_f32 v[182:183], v[134:135], v[42:43], v[182:183] op_sel_hi:[1,0,1]
  v_pk_mul_f32 v[168:169], v[168:169], v[44:45] op_sel_hi:[1,0]
  v_pk_mul_f32 v[170:171], v[170:171], v[44:45] op_sel_hi:[1,0]
  v_pk_mul_f32 v[172:173], v[172:173], v[44:45] op_sel_hi:[1,0]
  s_add_u32 s59, s55, 458752
  s_add_u32 m0, s51, 0
  s_nop 0
  buffer_load_dwordx4 v12, s[28:31], s59 offen offset:0 lds
  v_pk_mul_f32 v[174:175], v[174:175], v[44:45] op_sel_hi:[1,0]
  v_pk_mul_f32 v[176:177], v[176:177], v[44:45] op_sel_hi:[1,0]
  v_pk_mul_f32 v[178:179], v[178:179], v[44:45] op_sel_hi:[1,0]
  v_pk_mul_f32 v[180:181], v[180:181], v[44:45] op_sel_hi:[1,0]
  v_pk_mul_f32 v[182:183], v[182:183], v[44:45] op_sel_hi:[1,0]
  v_cvt_pk_bf16_f32 v216, v168, v169
  v_cvt_pk_bf16_f32 v217, v170, v171
  v_cvt_pk_bf16_f32 v218, v172, v173
  v_cvt_pk_bf16_f32 v219, v174, v175
  v_cvt_pk_bf16_f32 v220, v176, v177
  v_cvt_pk_bf16_f32 v221, v178, v179
  buffer_load_dwordx4 v13, s[28:31], s59 offen offset:1024 lds
  v_cvt_pk_bf16_f32 v222, v180, v181
  v_cvt_pk_bf16_f32 v223, v182, v183
  v_mfma_f32_32x32x16_bf16 v[200:215], v[160:163], v[216:219], 0
  s_nop 0
  v_mfma_f32_32x32x16_bf16 v[200:215], v[164:167], v[220:223], v[200:215]
  s_nop 11
  v_max3_f32 v216, v200, v201, v202
  v_max3_f32 v232, v208, v209, v210
  v_max3_f32 v217, -v200, -v201, -v202
  v_max3_f32 v233, -v208, -v209, -v210
  v_max3_f32 v216, v216, v203, v204
  v_max3_f32 v232, v232, v211, v212
  v_max3_f32 v217, v217, -v203, -v204
  v_max3_f32 v233, v233, -v211, -v212
  buffer_load_dwordx4 v14, s[28:31], s59 offen offset:2048 lds
  v_max3_f32 v216, v216, v205, v206
  v_max3_f32 v232, v232, v213, v214
  v_max3_f32 v217, v217, -v205, -v206
  v_max3_f32 v233, v233, -v213, -v214
  v_max_f32 v216, v216, v207
  v_max_f32 v232, v232, v215
  v_max_f32_e64 v217, v217, -v207
  v_max_f32_e64 v233, v233, -v215
  s_nop 0
  v_permlane32_swap_b32 v216, v217
  v_permlane32_swap_b32 v232, v233
  v_max_f32 v216, v216, v217
  buffer_load_dwordx4 v15, s[28:31], s59 offen offset:3072 lds
  v_max_f32 v232, v232, v233
  v_mul_f32 v218, 0xbfb8aa3b, v216
  v_mul_f32 v234, 0xbfb8aa3b, v232
  v_mul_f32 v220, 0xbfb8aa3b, v216
  v_mul_f32 v236, 0xbfb8aa3b, v232
  s_nop 0
  v_permlane32_swap_b32 v218, v220
  v_permlane32_swap_b32 v234, v236
  v_pk_fma_f32 v[168:169], v[200:201], s[68:69], v[218:219] op_sel_hi:[1,1,0]
  v_pk_fma_f32 v[120:121], v[208:209], s[68:69], v[234:235] op_sel_hi:[1,1,0]
  v_pk_fma_f32 v[176:177], v[200:201], s[68:69], v[220:221] op_sel_hi:[1,1,0] neg_lo:[1,0,0] neg_hi:[1,0,0]
  v_pk_fma_f32 v[128:129], v[208:209], s[68:69], v[236:237] op_sel_hi:[1,1,0] neg_lo:[1,0,0] neg_hi:[1,0,0]
  s_add_u32 s59, s55, 917504
  s_add_u32 m0, s51, 65536
  s_nop 0
  buffer_load_dwordx4 v12, s[28:31], s59 offen offset:0 lds
  v_pk_fma_f32 v[170:171], v[202:203], s[68:69], v[218:219] op_sel_hi:[1,1,0]
  v_pk_fma_f32 v[122:123], v[210:211], s[68:69], v[234:235] op_sel_hi:[1,1,0]
  v_pk_fma_f32 v[178:179], v[202:203], s[68:69], v[220:221] op_sel_hi:[1,1,0] neg_lo:[1,0,0] neg_hi:[1,0,0]
  v_pk_fma_f32 v[130:131], v[210:211], s[68:69], v[236:237] op_sel_hi:[1,1,0] neg_lo:[1,0,0] neg_hi:[1,0,0]
  v_pk_fma_f32 v[172:173], v[204:205], s[68:69], v[218:219] op_sel_hi:[1,1,0]
  v_pk_fma_f32 v[124:125], v[212:213], s[68:69], v[234:235] op_sel_hi:[1,1,0]
  v_pk_fma_f32 v[180:181], v[204:205], s[68:69], v[220:221] op_sel_hi:[1,1,0] neg_lo:[1,0,0] neg_hi:[1,0,0]
  s_add_u32 s60, s2, 18161664
  s_waitcnt vmcnt(5)
  buffer_store_dword v3, v34, s[40:43], s60 offen sc1
  v_lshlrev_b32 v253, 7, v1
  s_lshl3_add_u32 s60, s48, s49
  s_lshl2_add_u32 s60, s60, s50
  s_mul_i32 s61, s60, 1792
  s_lshl_b32 s60, s60, 9
  s_mov_b64 exec, 0x3fff
  buffer_load_dword v252, v253, s[32:35], s61 offen
  s_mov_b64 exec, 15
  buffer_load_dword v252, v253, s[16:19], s60 offen
  s_mov_b64 exec, -1
  v_pk_fma_f32 v[132:133], v[212:213], s[68:69], v[236:237] op_sel_hi:[1,1,0] neg_lo:[1,0,0] neg_hi:[1,0,0]
  v_pk_fma_f32 v[174:175], v[206:207], s[68:69], v[218:219] op_sel_hi:[1,1,0]
  v_pk_fma_f32 v[126:127], v[214:215], s[68:69], v[234:235] op_sel_hi:[1,1,0]
  v_pk_fma_f32 v[182:183], v[206:207], s[68:69], v[220:221] op_sel_hi:[1,1,0] neg_lo:[1,0,0] neg_hi:[1,0,0]
  v_pk_fma_f32 v[134:135], v[214:215], s[68:69], v[236:237] op_sel_hi:[1,1,0] neg_lo:[1,0,0] neg_hi:[1,0,0]
  buffer_load_dwordx4 v13, s[28:31], s59 offen offset:1024 lds
  v_exp_f32 v168, v168
  v_exp_f32 v120, v120
  v_exp_f32 v169, v169
  v_exp_f32 v121, v121
  v_exp_f32 v170, v170
  v_exp_f32 v122, v122
  v_exp_f32 v171, v171
  v_exp_f32 v123, v123
  v_exp_f32 v172, v172
  v_exp_f32 v124, v124
  v_exp_f32 v173, v173
  buffer_load_dwordx4 v14, s[28:31], s59 offen offset:2048 lds
  v_exp_f32 v125, v125
  v_exp_f32 v174, v174
  v_exp_f32 v126, v126
  v_exp_f32 v175, v175
  v_exp_f32 v127, v127
  v_exp_f32 v176, v176
  v_exp_f32 v128, v128
  v_exp_f32 v177, v177
  v_exp_f32 v129, v129
  v_exp_f32 v178, v178
  v_exp_f32 v130, v130
  buffer_load_dwordx4 v15, s[28:31], s59 offen offset:3072 lds
  v_exp_f32 v179, v179
  v_exp_f32 v131, v131
  v_exp_f32 v180, v180
  v_exp_f32 v132, v132
  v_exp_f32 v181, v181
  v_exp_f32 v133, v133
  v_exp_f32 v182, v182
  v_exp_f32 v134, v134
  v_exp_f32 v183, v183
  v_exp_f32 v135, v135
  v_pk_add_f32 v[216:217], v[168:169], v[170:171]
  v_pk_add_f32 v[232:233], v[120:121], v[122:123]
  s_add_u32 s59, s55, 1376256
  s_add_u32 m0, s51, 16384
  s_nop 0
  buffer_load_dwordx4 v12, s[28:31], s59 offen offset:0 lds
  v_pk_add_f32 v[218:219], v[176:177], v[178:179]
  v_pk_add_f32 v[234:235], v[128:129], v[130:131]
  v_pk_add_f32 v[220:221], v[172:173], v[174:175]
  v_pk_add_f32 v[236:237], v[124:125], v[126:127]
  v_pk_add_f32 v[222:223], v[180:181], v[182:183]
  v_pk_add_f32 v[238:239], v[132:133], v[134:135]
  v_pk_add_f32 v[216:217], v[216:217], v[220:221]
  v_pk_add_f32 v[232:233], v[232:233], v[236:237]
  v_pk_add_f32 v[218:219], v[218:219], v[222:223]
  v_pk_add_f32 v[234:235], v[234:235], v[238:239]
  v_add_f32 v216, v216, v217
  buffer_load_dwordx4 v13, s[28:31], s59 offen offset:1024 lds
  v_add_f32 v232, v232, v233
  v_add_f32 v218, v218, v219
  v_add_f32 v234, v234, v235
  s_nop 0
  v_permlane32_swap_b32 v216, v218
  v_permlane32_swap_b32 v232, v234
  v_add_f32 v216, v216, v218
  v_add_f32 v232, v232, v234
  v_rcp_f32 v216, v216
  v_rcp_f32 v232, v232
  v_mov_b32 v218, v216
  v_mov_b32 v234, v232
  buffer_load_dwordx4 v14, s[28:31], s59 offen offset:2048 lds
  v_permlane32_swap_b32 v216, v218
  v_permlane32_swap_b32 v232, v234
  v_pk_mul_f32 v[168:169], v[168:169], v[216:217] op_sel_hi:[1,0]
  v_pk_mul_f32 v[120:121], v[120:121], v[232:233] op_sel_hi:[1,0]
  v_pk_mul_f32 v[176:177], v[176:177], v[218:219] op_sel_hi:[1,0]
  v_pk_mul_f32 v[128:129], v[128:129], v[234:235] op_sel_hi:[1,0]
  v_pk_mul_f32 v[170:171], v[170:171], v[216:217] op_sel_hi:[1,0]
  v_pk_mul_f32 v[122:123], v[122:123], v[232:233] op_sel_hi:[1,0]
  v_pk_mul_f32 v[178:179], v[178:179], v[218:219] op_sel_hi:[1,0]
  v_pk_mul_f32 v[130:131], v[130:131], v[234:235] op_sel_hi:[1,0]
  v_pk_mul_f32 v[172:173], v[172:173], v[216:217] op_sel_hi:[1,0]
  v_pk_mul_f32 v[124:125], v[124:125], v[232:233] op_sel_hi:[1,0]
  buffer_load_dwordx4 v15, s[28:31], s59 offen offset:3072 lds
  v_pk_mul_f32 v[180:181], v[180:181], v[218:219] op_sel_hi:[1,0]
  v_pk_mul_f32 v[132:133], v[132:133], v[234:235] op_sel_hi:[1,0]
  v_pk_mul_f32 v[174:175], v[174:175], v[216:217] op_sel_hi:[1,0]
  v_pk_mul_f32 v[126:127], v[126:127], v[232:233] op_sel_hi:[1,0]
  v_pk_mul_f32 v[182:183], v[182:183], v[218:219] op_sel_hi:[1,0]
  v_pk_mul_f32 v[134:135], v[134:135], v[234:235] op_sel_hi:[1,0]
  v_cvt_pk_bf16_f32 v104, v168, v169
  v_cvt_pk_bf16_f32 v112, v120, v121
  v_cvt_pk_bf16_f32 v105, v170, v171
  v_cvt_pk_bf16_f32 v113, v122, v123
  v_cvt_pk_bf16_f32 v106, v172, v173
  v_cvt_pk_bf16_f32 v114, v124, v125
  v_cvt_pk_bf16_f32 v107, v174, v175
  v_cvt_pk_bf16_f32 v115, v126, v127
  v_cvt_pk_bf16_f32 v108, v176, v177
  v_cvt_pk_bf16_f32 v116, v128, v129
  v_cvt_pk_bf16_f32 v109, v178, v179
  v_cvt_pk_bf16_f32 v117, v130, v131
  v_cvt_pk_bf16_f32 v110, v180, v181
  v_cvt_pk_bf16_f32 v118, v132, v133
  v_cvt_pk_bf16_f32 v111, v182, v183
  v_cvt_pk_bf16_f32 v119, v134, v135
  v_mfma_f32_32x32x16_bf16 v[120:135], v[104:107], v[152:155], 0
  v_mfma_f32_32x32x16_bf16 v[120:135], v[108:111], v[156:159], v[120:135]
  v_mfma_f32_32x32x16_bf16 v[136:151], v[112:115], v[152:155], 0
  v_mfma_f32_32x32x16_bf16 v[136:151], v[116:119], v[156:159], v[136:151]
  s_lshl_b32 s60, s66, 7
  s_add_u32 s60, s60, 152576
  v_add_u32 v212, s60, v38
  v_and_b32 v213, 31, v1
  s_lshl_b32 s60, s67, 7
  s_add_u32 s60, s60, 159232
  v_lshl_add_u32 v213, v213, 2, s60
  ds_read_b32 v214, v213
  ds_read_b128 v[216:219], v212 offset:0
  ds_read_b128 v[232:235], v212 offset:256
  ds_read_b128 v[220:223], v212 offset:32
  ds_read_b128 v[236:239], v212 offset:288
  ds_read_b128 v[224:227], v212 offset:64
  ds_read_b128 v[240:243], v212 offset:320
  ds_read_b128 v[228:231], v212 offset:96
  ds_read_b128 v[244:247], v212 offset:352
  v_and_b32 v212, 16, v1
  v_cmp_eq_u32 vcc, 0, v212
  v_mov_b32 v213, s58
  s_waitcnt lgkmcnt(7)
  v_pk_fma_f32 v[184:185], v[216:217], v[214:215], v[184:185] op_sel_hi:[1,0,1] neg_lo:[1,0,0] neg_hi:[1,0,0]
  v_pk_fma_f32 v[186:187], v[218:219], v[214:215], v[186:187] op_sel_hi:[1,0,1] neg_lo:[1,0,0] neg_hi:[1,0,0]
  s_waitcnt lgkmcnt(5)
  v_pk_fma_f32 v[188:189], v[220:221], v[214:215], v[188:189] op_sel_hi:[1,0,1] neg_lo:[1,0,0] neg_hi:[1,0,0]
  v_pk_fma_f32 v[190:191], v[222:223], v[214:215], v[190:191] op_sel_hi:[1,0,1] neg_lo:[1,0,0] neg_hi:[1,0,0]
  s_waitcnt lgkmcnt(3)
  v_pk_fma_f32 v[192:193], v[224:225], v[214:215], v[192:193] op_sel_hi:[1,0,1] neg_lo:[1,0,0] neg_hi:[1,0,0]
  v_pk_fma_f32 v[194:195], v[226:227], v[214:215], v[194:195] op_sel_hi:[1,0,1] neg_lo:[1,0,0] neg_hi:[1,0,0]
  s_waitcnt lgkmcnt(1)
  v_pk_fma_f32 v[196:197], v[228:229], v[214:215], v[196:197] op_sel_hi:[1,0,1] neg_lo:[1,0,0] neg_hi:[1,0,0]
  v_pk_fma_f32 v[198:199], v[230:231], v[214:215], v[198:199] op_sel_hi:[1,0,1] neg_lo:[1,0,0] neg_hi:[1,0,0]
  v_pk_mul_f32 v[184:185], v[184:185], v[232:233]
  v_pk_mul_f32 v[186:187], v[186:187], v[234:235]
  v_pk_mul_f32 v[188:189], v[188:189], v[236:237]
  v_pk_mul_f32 v[190:191], v[190:191], v[238:239]
  v_pk_mul_f32 v[192:193], v[192:193], v[240:241]
  v_pk_mul_f32 v[194:195], v[194:195], v[242:243]
  s_waitcnt lgkmcnt(0)
  v_pk_mul_f32 v[196:197], v[196:197], v[244:245]
  v_pk_mul_f32 v[198:199], v[198:199], v[246:247]
  v_cvt_pk_bf16_f32 v168, v184, v185
  v_cvt_pk_bf16_f32 v169, v186, v187
  v_cvt_pk_bf16_f32 v170, v188, v189
  v_cvt_pk_bf16_f32 v171, v190, v191
  v_cvt_pk_bf16_f32 v172, v192, v193
  v_cvt_pk_bf16_f32 v173, v194, v195
  v_cvt_pk_bf16_f32 v174, v196, v197
  v_cvt_pk_bf16_f32 v175, v198, v199
  v_cndmask_b32 v176, v213, v168, vcc
  v_cndmask_b32 v200, v168, v213, vcc
  v_cndmask_b32 v177, v213, v169, vcc
  v_cndmask_b32 v201, v169, v213, vcc
  v_cndmask_b32 v178, v213, v170, vcc
  v_cndmask_b32 v202, v170, v213, vcc
  v_cndmask_b32 v179, v213, v171, vcc
  v_cndmask_b32 v203, v171, v213, vcc
  v_cndmask_b32 v180, v213, v172, vcc
  v_cndmask_b32 v204, v172, v213, vcc
  v_cndmask_b32 v181, v213, v173, vcc
  v_cndmask_b32 v205, v173, v213, vcc
  v_cndmask_b32 v182, v213, v174, vcc
  v_cndmask_b32 v206, v174, v213, vcc
  v_cndmask_b32 v183, v213, v175, vcc
  v_cndmask_b32 v207, v175, v213, vcc
  v_cvt_pk_bf16_f32 v216, v120, v121
  v_cvt_pk_bf16_f32 v217, v122, v123
  v_cvt_pk_bf16_f32 v218, v124, v125
  v_cvt_pk_bf16_f32 v219, v126, v127
  v_cvt_pk_bf16_f32 v220, v128, v129
  v_cvt_pk_bf16_f32 v221, v130, v131
  v_cvt_pk_bf16_f32 v222, v132, v133
  v_cvt_pk_bf16_f32 v223, v134, v135
  v_cvt_pk_bf16_f32 v224, v136, v137
  v_cvt_pk_bf16_f32 v225, v138, v139
  v_cvt_pk_bf16_f32 v226, v140, v141
  v_cvt_pk_bf16_f32 v227, v142, v143
  v_cvt_pk_bf16_f32 v228, v144, v145
  v_cvt_pk_bf16_f32 v229, v146, v147
  v_cvt_pk_bf16_f32 v230, v148, v149
  v_cvt_pk_bf16_f32 v231, v150, v151
  v_mfma_f32_32x32x16_bf16 v[120:135], v[216:219], v[176:179], 0
  v_mfma_f32_32x32x16_bf16 v[136:151], v[224:227], v[200:203], 0
  v_mfma_f32_32x32x16_bf16 v[120:135], v[220:223], v[180:183], v[120:135]
  v_mfma_f32_32x32x16_bf16 v[136:151], v[228:231], v[204:207], v[136:151]
  s_cmp_eq_u32 s66, 0
  s_cselect_b64 vcc, -1, 0
  s_lshl1_add_u32 s61, s3, s66
  s_lshl_b32 s70, s61, 5
  s_add_u32 s70, s70, s48
  s_lshl_b32 s70, s70, 2
  s_lshl_b32 s61, s61, 7
  s_add_u32 s61, s61, s48
  s_lshl_b32 s61, s61, 10
  s_add_u32 s61, s61, 13631488
  s_nop 1
  v_cndmask_b32 v216, v120, v136, vcc
  v_cndmask_b32 v217, v121, v137, vcc
  v_cndmask_b32 v218, v122, v138, vcc
  v_cndmask_b32 v219, v123, v139, vcc
  v_cndmask_b32 v220, v124, v140, vcc
  v_cndmask_b32 v221, v125, v141, vcc
  v_cndmask_b32 v222, v126, v142, vcc
  v_cndmask_b32 v223, v127, v143, vcc
  v_cndmask_b32 v224, v128, v144, vcc
  v_cndmask_b32 v225, v129, v145, vcc
  v_cndmask_b32 v226, v130, v146, vcc
  v_cndmask_b32 v227, v131, v147, vcc
  v_cndmask_b32 v228, v132, v148, vcc
  v_cndmask_b32 v229, v133, v149, vcc
  v_cndmask_b32 v230, v134, v150, vcc
  v_cndmask_b32 v231, v135, v151, vcc
  s_barrier
  v_add_u32 v212, s51, v2
  v_add_u32 v212, 131072, v212
  v_xor_b32 v213, 8192, v212
  ds_write_b128 v212, v[216:219] offset:0
  ds_write_b128 v212, v[220:223] offset:1024
  ds_write_b128 v212, v[224:227] offset:2048
  ds_write_b128 v212, v[228:231] offset:3072
  v_cndmask_b32 v232, v136, v120, vcc
  v_cndmask_b32 v233, v137, v121, vcc
  v_cndmask_b32 v234, v138, v122, vcc
  v_cndmask_b32 v235, v139, v123, vcc
  v_cndmask_b32 v236, v140, v124, vcc
  v_cndmask_b32 v237, v141, v125, vcc
  v_cndmask_b32 v238, v142, v126, vcc
  v_cndmask_b32 v239, v143, v127, vcc
  v_cndmask_b32 v240, v144, v128, vcc
  v_cndmask_b32 v241, v145, v129, vcc
  v_cndmask_b32 v242, v146, v130, vcc
  v_cndmask_b32 v243, v147, v131, vcc
  v_cndmask_b32 v244, v148, v132, vcc
  v_cndmask_b32 v245, v149, v133, vcc
  v_cndmask_b32 v246, v150, v134, vcc
  v_cndmask_b32 v247, v151, v135, vcc
  s_waitcnt lgkmcnt(0)
  s_barrier
  ds_read_b128 v[216:219], v213 offset:0
  ds_read_b128 v[220:223], v213 offset:1024
  ds_read_b128 v[224:227], v213 offset:2048
  ds_read_b128 v[228:231], v213 offset:3072
  s_waitcnt lgkmcnt(3)
  v_pk_add_f32 v[232:233], v[232:233], v[216:217]
  v_pk_add_f32 v[234:235], v[234:235], v[218:219]
  buffer_store_dwordx4 v[232:235], v2, s[40:43], s61 offen sc1
  s_add_u32 s61, s61, 32768
  s_waitcnt lgkmcnt(2)
  v_pk_add_f32 v[236:237], v[236:237], v[220:221]
  v_pk_add_f32 v[238:239], v[238:239], v[222:223]
  buffer_store_dwordx4 v[236:239], v2, s[40:43], s61 offen sc1
  s_add_u32 s61, s61, 32768
  s_waitcnt lgkmcnt(1)
  v_pk_add_f32 v[240:241], v[240:241], v[224:225]
  v_pk_add_f32 v[242:243], v[242:243], v[226:227]
  buffer_store_dwordx4 v[240:243], v2, s[40:43], s61 offen sc1
  s_add_u32 s61, s61, 32768
  s_waitcnt lgkmcnt(0)
  v_pk_add_f32 v[244:245], v[244:245], v[228:229]
  v_pk_add_f32 v[246:247], v[246:247], v[230:231]
  buffer_store_dwordx4 v[244:247], v2, s[40:43], s61 offen sc1
  v_and_b32 v36, 15, v1
  s_lshl_b32 s60, s64, 7
  s_add_u32 s60, s60, 18161664
  v_lshl_add_u32 v36, v36, 2, s60
  s_barrier
  ds_read_b64_tr_b16 v[80:81], v17 offset:16384
  ds_read_b64_tr_b16 v[82:83], v17 offset:16896
  ds_read_b64_tr_b16 v[84:85], v20 offset:18432
  ds_read_b64_tr_b16 v[86:87], v20 offset:18944
  ds_read_b64_tr_b16 v[88:89], v17 offset:20480
  ds_read_b64_tr_b16 v[90:91], v17 offset:20992
  ds_read_b64_tr_b16 v[92:93], v20 offset:22528
  ds_read_b64_tr_b16 v[94:95], v20 offset:23040
  ds_read_b64_tr_b16 v[96:97], v17 offset:24576
  ds_read_b64_tr_b16 v[98:99], v17 offset:25088
  s_waitcnt lgkmcnt(8)
  v_mfma_f32_32x32x16_bf16 v[168:183], v[80:83], a[0:3], 0
  ds_read_b64_tr_b16 v[100:101], v20 offset:26624
  ds_read_b64_tr_b16 v[102:103], v20 offset:27136
  s_waitcnt lgkmcnt(8)
  v_mfma_f32_32x32x16_bf16 v[168:183], v[84:87], a[4:7], v[168:183]
  s_add_u32 s59, s55, 128
  s_add_u32 m0, s51, 131072
  s_nop 0
  buffer_load_dwordx4 v12, s[28:31], s59 offen offset:0 lds
  ds_read_b64_tr_b16 v[80:81], v17 offset:28672
  ds_read_b64_tr_b16 v[82:83], v17 offset:29184
  s_waitcnt lgkmcnt(8)
  v_mfma_f32_32x32x16_bf16 v[168:183], v[88:91], a[8:11], v[168:183]
  ds_read_b64_tr_b16 v[84:85], v20 offset:30720
  ds_read_b64_tr_b16 v[86:87], v20 offset:31232
  s_waitcnt lgkmcnt(8)
  v_mfma_f32_32x32x16_bf16 v[168:183], v[92:95], a[12:15], v[168:183]
  buffer_load_dwordx4 v13, s[28:31], s59 offen offset:1024 lds
  s_barrier
  ds_read_b64_tr_b16 v[88:89], v16 offset:32768
  ds_read_b64_tr_b16 v[90:91], v16 offset:33280
  s_waitcnt lgkmcnt(8)
  v_mfma_f32_32x32x16_bf16 v[168:183], v[96:99], a[16:19], v[168:183]
  ds_read_b64_tr_b16 v[92:93], v19 offset:34816
  ds_read_b64_tr_b16 v[94:95], v19 offset:35328
  s_waitcnt lgkmcnt(8)
  v_mfma_f32_32x32x16_bf16 v[168:183], v[100:103], a[20:23], v[168:183]
  buffer_load_dwordx4 v14, s[28:31], s59 offen offset:2048 lds
  ds_read_b64_tr_b16 v[96:97], v16 offset:36864
  ds_read_b64_tr_b16 v[98:99], v16 offset:37376
  s_waitcnt lgkmcnt(8)
  v_mfma_f32_32x32x16_bf16 v[168:183], v[80:83], a[24:27], v[168:183]
  ds_read_b64_tr_b16 v[100:101], v19 offset:38912
  ds_read_b64_tr_b16 v[102:103], v19 offset:39424
  s_waitcnt lgkmcnt(8)
  v_mfma_f32_32x32x16_bf16 v[168:183], v[84:87], a[28:31], v[168:183]
  buffer_load_dwordx4 v15, s[28:31], s59 offen offset:3072 lds
  ds_read_b64_tr_b16 v[80:81], v16 offset:40960
  ds_read_b64_tr_b16 v[82:83], v16 offset:41472
  s_waitcnt lgkmcnt(8)
  v_mfma_f32_32x32x16_bf16 v[168:183], v[88:91], a[32:35], v[168:183]
  ds_read_b64_tr_b16 v[84:85], v19 offset:43008
  ds_read_b64_tr_b16 v[86:87], v19 offset:43520
  s_waitcnt lgkmcnt(8)
  v_mfma_f32_32x32x16_bf16 v[168:183], v[92:95], a[36:39], v[168:183]
  ds_read_b64_tr_b16 v[88:89], v16 offset:45056
  ds_read_b64_tr_b16 v[90:91], v16 offset:45568
  s_waitcnt lgkmcnt(8)
  v_mfma_f32_32x32x16_bf16 v[168:183], v[96:99], a[40:43], v[168:183]
  ds_read_b64_tr_b16 v[92:93], v19 offset:47104
  ds_read_b64_tr_b16 v[94:95], v19 offset:47616
  s_waitcnt lgkmcnt(8)
  v_mfma_f32_32x32x16_bf16 v[168:183], v[100:103], a[44:47], v[168:183]
  s_barrier
  ds_read_b64_tr_b16 v[96:97], v17 offset:32768
  ds_read_b64_tr_b16 v[98:99], v17 offset:33280
  s_waitcnt lgkmcnt(8)
  v_mfma_f32_32x32x16_bf16 v[168:183], v[80:83], a[48:51], v[168:183]
  s_add_u32 s60, s70, 18194432
  s_waitcnt vmcnt(4)
  buffer_store_dword v3, v34, s[40:43], s60 offen sc1
  ds_read_b64_tr_b16 v[100:101], v20 offset:34816
  ds_read_b64_tr_b16 v[102:103], v20 offset:35328
  s_waitcnt lgkmcnt(8)
  v_mfma_f32_32x32x16_bf16 v[168:183], v[84:87], a[52:55], v[168:183]
  s_add_u32 s59, s55, 458880
  s_add_u32 m0, s51, 81920
  s_nop 0
  buffer_load_dwordx4 v12, s[28:31], s59 offen offset:0 lds
  ds_read_b64_tr_b16 v[80:81], v17 offset:36864
  ds_read_b64_tr_b16 v[82:83], v17 offset:37376
  s_waitcnt lgkmcnt(8)
  v_mfma_f32_32x32x16_bf16 v[168:183], v[88:91], a[56:59], v[168:183]
  s_and_b32 s61, s48, 7
  s_and_b32 s60, s49, 3
  s_lshl2_add_u32 s61, s61, s60
  s_lshl2_add_u32 s61, s61, s50
  s_or_b32 s60, s49, 3
  s_lshl_b32 s60, s60, 7
  v_lshlrev_b32 v255, 10, v1
  s_mul_i32 s62, s61, 14336
  s_add_u32 s62, s62, s60
  s_mov_b64 exec, 0x3fff
  buffer_load_dword v254, v255, s[32:35], s62 offen
  s_mov_b64 exec, 15
  s_lshl_b32 s62, s61, 12
  s_add_u32 s62, s62, s60
  buffer_load_dword v254, v255, s[16:19], s62 offen
  s_mov_b64 exec, -1
  ds_read_b64_tr_b16 v[84:85], v20 offset:38912
  ds_read_b64_tr_b16 v[86:87], v20 offset:39424
  s_waitcnt lgkmcnt(8)
  v_mfma_f32_32x32x16_bf16 v[168:183], v[92:95], a[60:63], v[168:183]
  buffer_load_dwordx4 v13, s[28:31], s59 offen offset:1024 lds
  ds_read_b64_tr_b16 v[88:89], v17 offset:40960
  ds_read_b64_tr_b16 v[90:91], v17 offset:41472
  s_waitcnt lgkmcnt(8)
  v_mfma_f32_32x32x16_bf16 v[168:183], v[96:99], a[64:67], v[168:183]
  ds_read_b64_tr_b16 v[92:93], v20 offset:43008
  ds_read_b64_tr_b16 v[94:95], v20 offset:43520
  s_waitcnt lgkmcnt(8)
  v_mfma_f32_32x32x16_bf16 v[168:183], v[100:103], a[68:71], v[168:183]
  buffer_load_dwordx4 v14, s[28:31], s59 offen offset:2048 lds
  ds_read_b64_tr_b16 v[96:97], v17 offset:45056
  ds_read_b64_tr_b16 v[98:99], v17 offset:45568
  s_waitcnt lgkmcnt(8)
  v_mfma_f32_32x32x16_bf16 v[168:183], v[80:83], a[72:75], v[168:183]
  ds_read_b64_tr_b16 v[100:101], v20 offset:47104
  ds_read_b64_tr_b16 v[102:103], v20 offset:47616
  s_waitcnt lgkmcnt(8)
  v_mfma_f32_32x32x16_bf16 v[168:183], v[84:87], a[76:79], v[168:183]
  buffer_load_dwordx4 v15, s[28:31], s59 offen offset:3072 lds
  s_barrier
  ds_read_b64_tr_b16 v[80:81], v16 offset:49152
  ds_read_b64_tr_b16 v[82:83], v16 offset:49664
  s_waitcnt lgkmcnt(8)
  v_mfma_f32_32x32x16_bf16 v[168:183], v[88:91], a[80:83], v[168:183]
  ds_read_b64_tr_b16 v[84:85], v19 offset:51200
  ds_read_b64_tr_b16 v[86:87], v19 offset:51712
  s_waitcnt lgkmcnt(8)
  v_mfma_f32_32x32x16_bf16 v[168:183], v[92:95], a[84:87], v[168:183]
  s_add_u32 s59, s55, 917632
  s_add_u32 m0, s51, 32768
  s_nop 0
  buffer_load_dwordx4 v12, s[28:31], s59 offen offset:0 lds
  ds_read_b64_tr_b16 v[88:89], v16 offset:53248
  ds_read_b64_tr_b16 v[90:91], v16 offset:53760
  s_waitcnt lgkmcnt(8)
  v_mfma_f32_32x32x16_bf16 v[168:183], v[96:99], a[88:91], v[168:183]
  buffer_load_dword v35, v36, s[40:43], 0 offen sc1
  ds_read_b64_tr_b16 v[92:93], v19 offset:55296
  ds_read_b64_tr_b16 v[94:95], v19 offset:55808
  s_waitcnt lgkmcnt(8)
  v_mfma_f32_32x32x16_bf16 v[168:183], v[100:103], a[92:95], v[168:183]
  buffer_load_dwordx4 v13, s[28:31], s59 offen offset:1024 lds
  ds_read_b64_tr_b16 v[96:97], v16 offset:57344
  ds_read_b64_tr_b16 v[98:99], v16 offset:57856
  s_waitcnt lgkmcnt(8)
  v_mfma_f32_32x32x16_bf16 v[168:183], v[80:83], a[96:99], v[168:183]
  ds_read_b64_tr_b16 v[100:101], v19 offset:59392
  ds_read_b64_tr_b16 v[102:103], v19 offset:59904
  s_waitcnt lgkmcnt(8)
  v_mfma_f32_32x32x16_bf16 v[168:183], v[84:87], a[100:103], v[168:183]
  buffer_load_dwordx4 v14, s[28:31], s59 offen offset:2048 lds
  ds_read_b64_tr_b16 v[80:81], v16 offset:61440
  ds_read_b64_tr_b16 v[82:83], v16 offset:61952
  s_waitcnt lgkmcnt(8)
  v_mfma_f32_32x32x16_bf16 v[168:183], v[88:91], a[104:107], v[168:183]
  ds_read_b64_tr_b16 v[84:85], v19 offset:63488
  ds_read_b64_tr_b16 v[86:87], v19 offset:64000
  s_waitcnt lgkmcnt(8)
  v_mfma_f32_32x32x16_bf16 v[168:183], v[92:95], a[108:111], v[168:183]
  buffer_load_dwordx4 v15, s[28:31], s59 offen offset:3072 lds
  s_waitcnt lgkmcnt(6)
  v_mfma_f32_32x32x16_bf16 v[168:183], v[96:99], a[112:115], v[168:183]
  s_waitcnt lgkmcnt(4)
  v_mfma_f32_32x32x16_bf16 v[168:183], v[100:103], a[116:119], v[168:183]
  s_waitcnt lgkmcnt(2)
  v_mfma_f32_32x32x16_bf16 v[168:183], v[80:83], a[120:123], v[168:183]
  s_waitcnt lgkmcnt(0)
  v_mfma_f32_32x32x16_bf16 v[168:183], v[84:87], a[124:127], v[168:183]
  s_lshl_b32 s71, s64, 15
  s_add_u32 s71, s71, 2097152
  s_lshl_b32 s62, s64, 12
  s_add_u32 s62, s62, 17891328
  v_lshlrev_b32 v200, 2, v1
  s_mul_i32 s70, s64, 14
  s_add_u32 s70, s70, s65
  s_lshl_b32 s70, s70, 13
  s_add_u32 s70, s70, 6291456
  s_waitcnt vmcnt(3)
  v_cmp_ne_u32 vcc, v3, v35
  s_nop 0
  s_cbranch_vccz L_ok_9
  s_mov_b32 s63, 200000
L_spin_10:
  buffer_load_dword v35, v36, s[40:43], 0 offen sc1
  s_waitcnt vmcnt(0)
  v_cmp_ne_u32 vcc, v3, v35
  s_nop 0
  s_cbranch_vccz L_ok_9
  s_sub_u32 s63, s63, 1
  s_cbranch_scc0 L_spin_10
L_ok_9:
  buffer_load_dwordx4 a[128:131], v2, s[44:47], s71 offen offset:0 sc1
  buffer_load_dwordx4 a[132:135], v2, s[44:47], s71 offen offset:1024 sc1
  buffer_load_dwordx4 a[136:139], v2, s[44:47], s71 offen offset:2048 sc1
  buffer_load_dwordx4 a[140:143], v2, s[44:47], s71 offen offset:3072 sc1
  s_add_u32 s71, s71, 4096
  buffer_load_dwordx4 a[144:147], v2, s[44:47], s71 offen offset:0 sc1
  buffer_load_dwordx4 a[148:151], v2, s[44:47], s71 offen offset:1024 sc1
  buffer_load_dwordx4 a[152:155], v2, s[44:47], s71 offen offset:2048 sc1
  buffer_load_dwordx4 a[156:159], v2, s[44:47], s71 offen offset:3072 sc1
  s_add_u32 s71, s71, 4096
  buffer_load_dwordx4 a[160:163], v2, s[44:47], s71 offen offset:0 sc1
  buffer_load_dwordx4 a[164:167], v2, s[44:47], s71 offen offset:1024 sc1
  v_and_b32 v36, 31, v1
  s_lshr_b32 s61, s48, 3
  s_lshl2_add_u32 s60, s49, s61
  s_lshl_b32 s60, s60, 7
  s_add_u32 s60, s60, 18194432
  v_lshl_add_u32 v36, v36, 2, s60
  s_mul_i32 s52, s73, 14
  s_add_u32 s52, s52, s67
  s_lshl_b32 s52, s52, 13
  s_add_u32 s52, s52, 6291456
  s_lshl3_add_u32 s54, s73, s67
  s_lshl_b32 s54, s54, 12
  s_add_u32 s54, s54, 4194304
  s_barrier
  ds_read_b64_tr_b16 v[80:81], v23 offset:49152
  ds_read_b64_tr_b16 v[82:83], v23 offset:50176
  ds_read_b64_tr_b16 v[84:85], v26 offset:49152
  ds_read_b64_tr_b16 v[86:87], v26 offset:50176
  ds_read_b64_tr_b16 v[88:89], v23 offset:51200
  ds_read_b64_tr_b16 v[90:91], v23 offset:52224
  ds_read_b64_tr_b16 v[92:93], v26 offset:51200
  ds_read_b64_tr_b16 v[94:95], v26 offset:52224
  ds_read_b64_tr_b16 v[96:97], v23 offset:53248
  ds_read_b64_tr_b16 v[98:99], v23 offset:54272
  s_waitcnt vmcnt(9) lgkmcnt(8)
  v_mfma_f32_32x32x16_bf16 v[104:119], v[80:83], a[128:131], 0
  buffer_load_dword v184, v200, s[44:47], s62 offen offset:0 sc1
  ds_read_b64_tr_b16 v[100:101], v26 offset:53248
  ds_read_b64_tr_b16 v[102:103], v26 offset:54272
  s_waitcnt lgkmcnt(8)
  v_mfma_f32_32x32x16_bf16 v[120:135], v[84:87], a[128:131], 0
  buffer_load_dwordx4 a[168:171], v2, s[44:47], s71 offen offset:2048 sc1
  ds_read_b64_tr_b16 v[80:81], v23 offset:55296
  ds_read_b64_tr_b16 v[82:83], v23 offset:56320
  s_waitcnt vmcnt(10) lgkmcnt(8)
  v_mfma_f32_32x32x16_bf16 v[104:119], v[88:91], a[132:135], v[104:119]
  buffer_load_dword v185, v200, s[44:47], s62 offen offset:256 sc1
  ds_read_b64_tr_b16 v[84:85], v26 offset:55296
  ds_read_b64_tr_b16 v[86:87], v26 offset:56320
  s_waitcnt lgkmcnt(8)
  v_mfma_f32_32x32x16_bf16 v[120:135], v[92:95], a[132:135], v[120:135]
  buffer_load_dwordx4 a[172:175], v2, s[44:47], s71 offen offset:3072 sc1
  ds_read_b64_tr_b16 v[88:89], v23 offset:57344
  ds_read_b64_tr_b16 v[90:91], v23 offset:58368
  s_waitcnt vmcnt(11) lgkmcnt(8)
  v_mfma_f32_32x32x16_bf16 v[104:119], v[96:99], a[136:139], v[104:119]
  buffer_load_dword v186, v200, s[44:47], s62 offen offset:512 sc1
  ds_read_b64_tr_b16 v[92:93], v26 offset:57344
  ds_read_b64_tr_b16 v[94:95], v26 offset:58368
  s_waitcnt lgkmcnt(8)
  v_mfma_f32_32x32x16_bf16 v[120:135], v[100:103], a[136:139], v[120:135]
  s_add_u32 s71, s71, 4096
  buffer_load_dwordx4 a[176:179], v2, s[44:47], s71 offen offset:0 sc1
  ds_read_b64_tr_b16 v[96:97], v23 offset:59392
  ds_read_b64_tr_b16 v[98:99], v23 offset:60416
  s_waitcnt vmcnt(12) lgkmcnt(8)
  v_mfma_f32_32x32x16_bf16 v[104:119], v[80:83], a[140:143], v[104:119]
  buffer_load_dword v187, v200, s[44:47], s62 offen offset:768 sc1
  ds_read_b64_tr_b16 v[100:101], v26 offset:59392
  ds_read_b64_tr_b16 v[102:103], v26 offset:60416
  s_waitcnt lgkmcnt(8)
  v_mfma_f32_32x32x16_bf16 v[120:135], v[84:87], a[140:143], v[120:135]
  buffer_load_dwordx4 a[180:183], v2, s[44:47], s71 offen offset:1024 sc1
  ds_read_b64_tr_b16 v[80:81], v23 offset:61440
  ds_read_b64_tr_b16 v[82:83], v23 offset:62464
  s_waitcnt vmcnt(13) lgkmcnt(8)
  v_mfma_f32_32x32x16_bf16 v[104:119], v[88:91], a[144:147], v[104:119]
  buffer_load_dword v188, v200, s[44:47], s62 offen offset:1024 sc1
  ds_read_b64_tr_b16 v[84:85], v26 offset:61440
  ds_read_b64_tr_b16 v[86:87], v26 offset:62464
  s_waitcnt lgkmcnt(8)
  v_mfma_f32_32x32x16_bf16 v[120:135], v[92:95], a[144:147], v[120:135]
  buffer_load_dwordx4 a[184:187], v2, s[44:47], s71 offen offset:2048 sc1
  ds_read_b64_tr_b16 v[88:89], v23 offset:63488
  ds_read_b64_tr_b16 v[90:91], v23 offset:64512
  s_waitcnt vmcnt(14) lgkmcnt(8)
  v_mfma_f32_32x32x16_bf16 v[104:119], v[96:99], a[148:151], v[104:119]
  buffer_load_dword v189, v200, s[44:47], s62 offen offset:1280 sc1
  ds_read_b64_tr_b16 v[92:93], v26 offset:63488
  ds_read_b64_tr_b16 v[94:95], v26 offset:64512
  s_waitcnt lgkmcnt(8)
  v_mfma_f32_32x32x16_bf16 v[120:135], v[100:103], a[148:151], v[120:135]
  buffer_load_dwordx4 a[188:191], v2, s[44:47], s71 offen offset:3072 sc1
  ds_read_b64_tr_b16 v[96:97], v22 offset:0
  ds_read_b64_tr_b16 v[98:99], v22 offset:1024
  s_waitcnt vmcnt(15) lgkmcnt(8)
  v_mfma_f32_32x32x16_bf16 v[104:119], v[80:83], a[152:155], v[104:119]
  buffer_load_dword v190, v200, s[44:47], s62 offen offset:1536 sc1
  ds_read_b64_tr_b16 v[100:101], v25 offset:0
  ds_read_b64_tr_b16 v[102:103], v25 offset:1024
  s_waitcnt lgkmcnt(8)
  v_mfma_f32_32x32x16_bf16 v[120:135], v[84:87], a[152:155], v[120:135]
  s_add_u32 s71, s71, 4096
  buffer_load_dwordx4 a[192:195], v2, s[44:47], s71 offen offset:0 sc1
  ds_read_b64_tr_b16 v[80:81], v22 offset:2048
  ds_read_b64_tr_b16 v[82:83], v22 offset:3072
  s_waitcnt vmcnt(16) lgkmcnt(8)
  v_mfma_f32_32x32x16_bf16 v[104:119], v[88:91], a[156:159], v[104:119]
  buffer_load_dword v191, v200, s[44:47], s62 offen offset:1792 sc1
  ds_read_b64_tr_b16 v[84:85], v25 offset:2048
  ds_read_b64_tr_b16 v[86:87], v25 offset:3072
  s_waitcnt lgkmcnt(8)
  v_mfma_f32_32x32x16_bf16 v[120:135], v[92:95], a[156:159], v[120:135]
  buffer_load_dwordx4 a[196:199], v2, s[44:47], s71 offen offset:1024 sc1
  ds_read_b64_tr_b16 v[88:89], v22 offset:4096
  ds_read_b64_tr_b16 v[90:91], v22 offset:5120
  s_waitcnt vmcnt(17) lgkmcnt(8)
  v_mfma_f32_32x32x16_bf16 v[104:119], v[96:99], a[160:163], v[104:119]
  buffer_load_dword v192, v200, s[44:47], s62 offen offset:2048 sc1
  ds_read_b64_tr_b16 v[92:93], v25 offset:4096
  ds_read_b64_tr_b16 v[94:95], v25 offset:5120
  s_waitcnt lgkmcnt(8)
  v_mfma_f32_32x32x16_bf16 v[120:135], v[100:103], a[160:163], v[120:135]
  buffer_load_dwordx4 a[200:203], v2, s[44:47], s71 offen offset:2048 sc1
  ds_read_b64_tr_b16 v[96:97], v22 offset:6144
  ds_read_b64_tr_b16 v[98:99], v22 offset:7168
  s_waitcnt vmcnt(18) lgkmcnt(8)
  v_mfma_f32_32x32x16_bf16 v[104:119], v[80:83], a[164:167], v[104:119]
  buffer_load_dword v193, v200, s[44:47], s62 offen offset:2304 sc1
  ds_read_b64_tr_b16 v[100:101], v25 offset:6144
  ds_read_b64_tr_b16 v[102:103], v25 offset:7168
  s_waitcnt lgkmcnt(8)
  v_mfma_f32_32x32x16_bf16 v[120:135], v[84:87], a[164:167], v[120:135]
  buffer_load_dwordx4 a[204:207], v2, s[44:47], s71 offen offset:3072 sc1
  ds_read_b64_tr_b16 v[80:81], v22 offset:8192
  ds_read_b64_tr_b16 v[82:83], v22 offset:9216
  s_waitcnt vmcnt(18) lgkmcnt(8)
  v_mfma_f32_32x32x16_bf16 v[104:119], v[88:91], a[168:171], v[104:119]
  buffer_load_dword v194, v200, s[44:47], s62 offen offset:2560 sc1
  ds_read_b64_tr_b16 v[84:85], v25 offset:8192
  ds_read_b64_tr_b16 v[86:87], v25 offset:9216
  s_waitcnt lgkmcnt(8)
  v_mfma_f32_32x32x16_bf16 v[120:135], v[92:95], a[168:171], v[120:135]
  s_add_u32 s71, s71, 4096
  buffer_load_dwordx4 a[208:211], v2, s[44:47], s71 offen offset:0 sc1
  ds_read_b64_tr_b16 v[88:89], v22 offset:10240
  ds_read_b64_tr_b16 v[90:91], v22 offset:11264
  s_waitcnt vmcnt(18) lgkmcnt(8)
  v_mfma_f32_32x32x16_bf16 v[104:119], v[96:99], a[172:175], v[104:119]
  buffer_load_dword v195, v200, s[44:47], s62 offen offset:2816 sc1
  ds_read_b64_tr_b16 v[92:93], v25 offset:10240
  ds_read_b64_tr_b16 v[94:95], v25 offset:11264
  s_waitcnt lgkmcnt(8)
  v_mfma_f32_32x32x16_bf16 v[120:135], v[100:103], a[172:175], v[120:135]
  buffer_load_dwordx4 a[212:215], v2, s[44:47], s71 offen offset:1024 sc1
  ds_read_b64_tr_b16 v[96:97], v22 offset:12288
  ds_read_b64_tr_b16 v[98:99], v22 offset:13312
  s_waitcnt vmcnt(18) lgkmcnt(8)
  v_mfma_f32_32x32x16_bf16 v[104:119], v[80:83], a[176:179], v[104:119]
  buffer_load_dword v196, v200, s[44:47], s62 offen offset:3072 sc1
  ds_read_b64_tr_b16 v[100:101], v25 offset:12288
  ds_read_b64_tr_b16 v[102:103], v25 offset:13312
  s_waitcnt lgkmcnt(8)
  v_mfma_f32_32x32x16_bf16 v[120:135], v[84:87], a[176:179], v[120:135]
  buffer_load_dwordx4 a[216:219], v2, s[44:47], s71 offen offset:2048 sc1
  ds_read_b64_tr_b16 v[80:81], v22 offset:14336
  ds_read_b64_tr_b16 v[82:83], v22 offset:15360
  s_waitcnt vmcnt(18) lgkmcnt(8)
  v_mfma_f32_32x32x16_bf16 v[104:119], v[88:91], a[180:183], v[104:119]
  buffer_load_dword v197, v200, s[44:47], s62 offen offset:3328 sc1
  ds_read_b64_tr_b16 v[84:85], v25 offset:14336
  ds_read_b64_tr_b16 v[86:87], v25 offset:15360
  s_waitcnt lgkmcnt(8)
  v_mfma_f32_32x32x16_bf16 v[120:135], v[92:95], a[180:183], v[120:135]
  buffer_load_dwordx4 a[220:223], v2, s[44:47], s71 offen offset:3072 sc1
  ds_read_b64_tr_b16 v[88:89], v23 offset:0
  ds_read_b64_tr_b16 v[90:91], v23 offset:1024
  s_waitcnt vmcnt(18) lgkmcnt(8)
  v_mfma_f32_32x32x16_bf16 v[104:119], v[96:99], a[184:187], v[104:119]
  buffer_load_dword v198, v200, s[44:47], s62 offen offset:3584 sc1
  ds_read_b64_tr_b16 v[92:93], v26 offset:0
  ds_read_b64_tr_b16 v[94:95], v26 offset:1024
  s_waitcnt lgkmcnt(8)
  v_mfma_f32_32x32x16_bf16 v[120:135], v[100:103], a[184:187], v[120:135]
  s_add_u32 s71, s71, 4096
  buffer_load_dwordx4 a[224:227], v2, s[44:47], s71 offen offset:0 sc1
  ds_read_b64_tr_b16 v[96:97], v23 offset:2048
  ds_read_b64_tr_b16 v[98:99], v23 offset:3072
  s_waitcnt vmcnt(18) lgkmcnt(8)
  v_mfma_f32_32x32x16_bf16 v[104:119], v[80:83], a[188:191], v[104:119]
  buffer_load_dword v199, v200, s[44:47], s62 offen offset:3840 sc1
  ds_read_b64_tr_b16 v[100:101], v26 offset:2048
  ds_read_b64_tr_b16 v[102:103], v26 offset:3072
  s_waitcnt lgkmcnt(8)
  v_mfma_f32_32x32x16_bf16 v[120:135], v[84:87], a[188:191], v[120:135]
  buffer_load_dwordx4 a[228:231], v2, s[44:47], s71 offen offset:1024 sc1
  ds_read_b64_tr_b16 v[80:81], v23 offset:4096
  ds_read_b64_tr_b16 v[82:83], v23 offset:5120
  s_waitcnt vmcnt(18) lgkmcnt(8)
  v_mfma_f32_32x32x16_bf16 v[104:119], v[88:91], a[192:195], v[104:119]
  ds_read_b64_tr_b16 v[84:85], v26 offset:4096
  ds_read_b64_tr_b16 v[86:87], v26 offset:5120
  s_waitcnt lgkmcnt(8)
  v_mfma_f32_32x32x16_bf16 v[120:135], v[92:95], a[192:195], v[120:135]
  buffer_load_dwordx4 a[232:235], v2, s[44:47], s71 offen offset:2048 sc1
  ds_read_b64_tr_b16 v[88:89], v23 offset:6144
  ds_read_b64_tr_b16 v[90:91], v23 offset:7168
  s_waitcnt vmcnt(17) lgkmcnt(8)
  v_mfma_f32_32x32x16_bf16 v[104:119], v[96:99], a[196:199], v[104:119]
  buffer_load_dword v35, v36, s[40:43], 0 offen sc1
  ds_read_b64_tr_b16 v[92:93], v26 offset:6144
  ds_read_b64_tr_b16 v[94:95], v26 offset:7168
  s_waitcnt lgkmcnt(8)
  v_mfma_f32_32x32x16_bf16 v[120:135], v[100:103], a[196:199], v[120:135]
  buffer_load_dwordx4 a[236:239], v2, s[44:47], s71 offen offset:3072 sc1
  ds_read_b64_tr_b16 v[96:97], v23 offset:8192
  ds_read_b64_tr_b16 v[98:99], v23 offset:9216
  s_waitcnt vmcnt(17) lgkmcnt(8)
  v_mfma_f32_32x32x16_bf16 v[104:119], v[80:83], a[200:203], v[104:119]
  v_add_f32 v184, v184, v192
  s_waitcnt vmcnt(16)
  v_add_f32 v185, v185, v193
  ds_read_b64_tr_b16 v[100:101], v26 offset:8192
  ds_read_b64_tr_b16 v[102:103], v26 offset:9216
  s_waitcnt lgkmcnt(8)
  v_mfma_f32_32x32x16_bf16 v[120:135], v[84:87], a[200:203], v[120:135]
  s_add_u32 s71, s71, 4096
  buffer_load_dwordx4 a[240:243], v2, s[44:47], s71 offen offset:0 sc1
  s_waitcnt vmcnt(15)
  v_add_f32 v186, v186, v194
  s_waitcnt vmcnt(13)
  v_add_f32 v187, v187, v195
  ds_read_b64_tr_b16 v[80:81], v23 offset:10240
  ds_read_b64_tr_b16 v[82:83], v23 offset:11264
  s_waitcnt lgkmcnt(8)
  v_mfma_f32_32x32x16_bf16 v[104:119], v[88:91], a[204:207], v[104:119]
  s_waitcnt vmcnt(11)
  v_add_f32 v188, v188, v196
  s_waitcnt vmcnt(9)
  v_add_f32 v189, v189, v197
  ds_read_b64_tr_b16 v[84:85], v26 offset:10240
  ds_read_b64_tr_b16 v[86:87], v26 offset:11264
  s_waitcnt lgkmcnt(8)
  v_mfma_f32_32x32x16_bf16 v[120:135], v[92:95], a[204:207], v[120:135]
  buffer_load_dwordx4 a[244:247], v2, s[44:47], s71 offen offset:1024 sc1
  s_waitcnt vmcnt(8)
  v_add_f32 v190, v190, v198
  s_waitcnt vmcnt(6)
  v_add_f32 v191, v191, v199
  ds_read_b64_tr_b16 v[88:89], v23 offset:12288
  ds_read_b64_tr_b16 v[90:91], v23 offset:13312
  s_waitcnt lgkmcnt(8)
  v_mfma_f32_32x32x16_bf16 v[104:119], v[96:99], a[208:211], v[104:119]
  v_add_f32 v184, v184, v188
  v_add_f32 v185, v185, v189
  ds_read_b64_tr_b16 v[92:93], v26 offset:12288
  ds_read_b64_tr_b16 v[94:95], v26 offset:13312
  s_waitcnt lgkmcnt(8)
  v_mfma_f32_32x32x16_bf16 v[120:135], v[100:103], a[208:211], v[120:135]
  buffer_load_dwordx4 a[248:251], v2, s[44:47], s71 offen offset:2048 sc1
  v_add_f32 v186, v186, v190
  v_add_f32 v187, v187, v191
  ds_read_b64_tr_b16 v[96:97], v23 offset:14336
  ds_read_b64_tr_b16 v[98:99], v23 offset:15360
  s_waitcnt lgkmcnt(8)
  v_mfma_f32_32x32x16_bf16 v[104:119], v[80:83], a[212:215], v[104:119]
  v_add_f32 v184, v184, v186
  v_add_f32 v185, v185, v187
  ds_read_b64_tr_b16 v[100:101], v26 offset:14336
  ds_read_b64_tr_b16 v[102:103], v26 offset:15360
  s_waitcnt lgkmcnt(8)
  v_mfma_f32_32x32x16_bf16 v[120:135], v[84:87], a[212:215], v[120:135]
  buffer_load_dwordx4 a[252:255], v2, s[44:47], s71 offen offset:3072 sc1
  v_add_f32 v68, v184, v185
  v_add_f32 v69, v184, v185
  ds_read_b64_tr_b16 v[80:81], v22 offset:16384
  ds_read_b64_tr_b16 v[82:83], v22 offset:17408
  s_waitcnt lgkmcnt(8)
  v_mfma_f32_32x32x16_bf16 v[104:119], v[88:91], a[216:219], v[104:119]
  v_add_u32 v78, 159488, v38
  s_nop 0
  ds_read_b64_tr_b16 v[84:85], v25 offset:16384
  ds_read_b64_tr_b16 v[86:87], v25 offset:17408
  s_waitcnt lgkmcnt(8)
  v_mfma_f32_32x32x16_bf16 v[120:135], v[92:95], a[216:219], v[120:135]
  s_add_u32 s59, s55, 1376384
  s_add_u32 m0, s51, 98304
  s_nop 0
  buffer_load_dwordx4 v12, s[28:31], s59 offen offset:0 lds
  v_permlane32_swap_b32 v68, v69
  v_mul_f32 v70, 0x3b000000, v68
  ds_read_b64_tr_b16 v[88:89], v22 offset:18432
  ds_read_b64_tr_b16 v[90:91], v22 offset:19456
  s_waitcnt lgkmcnt(8)
  v_mfma_f32_32x32x16_bf16 v[104:119], v[96:99], a[220:223], v[104:119]
  v_mul_f32 v69, 0x3b000000, v69
  v_fma_f32 v69, -v70, v70, v69
  ds_read_b64_tr_b16 v[92:93], v25 offset:18432
  ds_read_b64_tr_b16 v[94:95], v25 offset:19456
  s_waitcnt lgkmcnt(8)
  v_mfma_f32_32x32x16_bf16 v[120:135], v[100:103], a[220:223], v[120:135]
  buffer_load_dwordx4 v13, s[28:31], s59 offen offset:1024 lds
  v_max_f32 v69, 0, v69
  v_cvt_pk_bf16_f32 v69, v69, v69
  ds_read_b64_tr_b16 v[96:97], v22 offset:20480
  ds_read_b64_tr_b16 v[98:99], v22 offset:21504
  s_waitcnt lgkmcnt(8)
  v_mfma_f32_32x32x16_bf16 v[104:119], v[80:83], a[224:227], v[104:119]
  v_and_b32 v69, 0xffff0000, v69
  v_add_f32 v71, 0x3727c5ac, v69
  ds_read_b64_tr_b16 v[100:101], v25 offset:20480
  ds_read_b64_tr_b16 v[102:103], v25 offset:21504
  s_waitcnt lgkmcnt(8)
  v_mfma_f32_32x32x16_bf16 v[120:135], v[84:87], a[224:227], v[120:135]
  buffer_load_dwordx4 v14, s[28:31], s59 offen offset:2048 lds
  v_cvt_pk_bf16_f32 v71, v71, v71
  v_and_b32 v71, 0xffff0000, v71
  ds_read_b64_tr_b16 v[80:81], v22 offset:22528
  ds_read_b64_tr_b16 v[82:83], v22 offset:23552
  s_waitcnt vmcnt(10) lgkmcnt(8)
  v_mfma_f32_32x32x16_bf16 v[104:119], v[88:91], a[228:231], v[104:119]
  v_sqrt_f32 v68, v71
  v_cvt_pk_bf16_f32 v70, v70, v70
  ds_read_b64_tr_b16 v[84:85], v25 offset:22528
  ds_read_b64_tr_b16 v[86:87], v25 offset:23552
  s_waitcnt lgkmcnt(8)
  v_mfma_f32_32x32x16_bf16 v[120:135], v[92:95], a[228:231], v[120:135]
  buffer_load_dwordx4 v15, s[28:31], s59 offen offset:3072 lds
  v_and_b32 v70, 0xffff0000, v70
  v_cvt_pk_bf16_f32 v68, v68, v68
  ds_read_b64_tr_b16 v[88:89], v22 offset:24576
  ds_read_b64_tr_b16 v[90:91], v22 offset:25600
  s_waitcnt vmcnt(10) lgkmcnt(8)
  v_mfma_f32_32x32x16_bf16 v[104:119], v[96:99], a[232:235], v[104:119]
  v_and_b32 v68, 0xffff0000, v68
  v_rcp_f32 v79, v68
  ds_read_b64_tr_b16 v[92:93], v25 offset:24576
  ds_read_b64_tr_b16 v[94:95], v25 offset:25600
  s_waitcnt lgkmcnt(8)
  v_mfma_f32_32x32x16_bf16 v[120:135], v[100:103], a[232:235], v[120:135]
  s_add_u32 s59, s56, 0
  s_add_u32 m0, s51, 49152
  s_nop 0
  buffer_load_dwordx4 v4, s[32:35], s59 offen offset:0 lds
  v_sub_f32 v70, 0, v70
  v_mul_f32 v72, 0xc0135761, v79
  ds_read_b64_tr_b16 v[96:97], v22 offset:26624
  ds_read_b64_tr_b16 v[98:99], v22 offset:27648
  s_waitcnt vmcnt(9) lgkmcnt(8)
  v_mfma_f32_32x32x16_bf16 v[104:119], v[80:83], a[236:239], v[104:119]
  v_mul_f32 v76, v79, v79
  v_mul_f32 v76, v76, v79
  ds_read_b64_tr_b16 v[100:101], v25 offset:26624
  ds_read_b64_tr_b16 v[102:103], v25 offset:27648
  s_waitcnt lgkmcnt(8)
  v_mfma_f32_32x32x16_bf16 v[120:135], v[84:87], a[236:239], v[120:135]
  buffer_load_dwordx4 v5, s[32:35], s59 offen offset:1024 lds
  v_mul_f32 v76, 0xbdd2d3e8, v76
  ds_read_b64_tr_b16 v[80:81], v22 offset:28672
  ds_read_b64_tr_b16 v[82:83], v22 offset:29696
  s_waitcnt vmcnt(9) lgkmcnt(8)
  v_mfma_f32_32x32x16_bf16 v[104:119], v[88:91], a[240:243], v[104:119]
  ds_read_b64_tr_b16 v[84:85], v25 offset:28672
  ds_read_b64_tr_b16 v[86:87], v25 offset:29696
  s_waitcnt lgkmcnt(8)
  v_mfma_f32_32x32x16_bf16 v[120:135], v[92:95], a[240:243], v[120:135]
  buffer_load_dwordx4 v6, s[32:35], s59 offen offset:2048 lds
  ds_read_b64_tr_b16 v[88:89], v22 offset:30720
  ds_read_b64_tr_b16 v[90:91], v22 offset:31744
  s_waitcnt vmcnt(9) lgkmcnt(8)
  v_mfma_f32_32x32x16_bf16 v[104:119], v[96:99], a[244:247], v[104:119]
  v_cmp_ne_u32 vcc, v3, v35
  s_nop 0
  s_cbranch_vccz L_ok_11
  s_mov_b32 s63, 200000
L_spin_12:
  buffer_load_dword v35, v36, s[40:43], 0 offen sc1
  s_waitcnt vmcnt(0)
  v_cmp_ne_u32 vcc, v3, v35
  s_nop 0
  s_cbranch_vccz L_ok_11
  s_sub_u32 s63, s63, 1
  s_cbranch_scc0 L_spin_12
L_ok_11:
  v_lshrrev_b32 v248, 3, v1
  v_and_b32 v249, 7, v1
  v_lshlrev_b32 v249, 4, v249
  v_lshl_add_u32 v248, v248, 10, v249
  s_lshr_b32 s61, s48, 1
  s_lshl4_add_u32 s60, s49, s61
  s_lshl_b32 s60, s60, 8
  s_and_b32 s61, s48, 1
  s_lshl2_add_u32 s61, s61, s50
  s_add_u32 s60, s60, s61
  s_lshl_b32 s60, s60, 7
  s_add_u32 s62, s60, 13631488
  buffer_load_dwordx4 v[184:187], v248, s[40:43], s62 offen sc1
  s_add_u32 s62, s62, 8192
  ds_read_b64_tr_b16 v[92:93], v25 offset:30720
  ds_read_b64_tr_b16 v[94:95], v25 offset:31744
  s_waitcnt lgkmcnt(8)
  v_mfma_f32_32x32x16_bf16 v[120:135], v[100:103], a[244:247], v[120:135]
  buffer_load_dwordx4 v7, s[32:35], s59 offen offset:3072 lds
  s_waitcnt vmcnt(10) lgkmcnt(6)
  v_mfma_f32_32x32x16_bf16 v[104:119], v[80:83], a[248:251], v[104:119]
  buffer_load_dwordx4 v[188:191], v248, s[40:43], s62 offen sc1
  s_add_u32 s62, s62, 8192
  s_waitcnt lgkmcnt(4)
  v_mfma_f32_32x32x16_bf16 v[120:135], v[84:87], a[248:251], v[120:135]
  s_waitcnt vmcnt(10) lgkmcnt(2)
  v_mfma_f32_32x32x16_bf16 v[104:119], v[88:91], a[252:255], v[104:119]
  buffer_load_dwordx4 v[192:195], v248, s[40:43], s62 offen sc1
  s_add_u32 s62, s62, 8192
  s_waitcnt lgkmcnt(0)
  v_mfma_f32_32x32x16_bf16 v[120:135], v[92:95], a[252:255], v[120:135]
  buffer_load_dwordx4 v[196:199], v248, s[40:43], s62 offen sc1
  s_add_u32 s62, s62, 8192
  s_waitcnt vmcnt(8)
  s_barrier
  ds_read_b128 v[200:203], v78 offset:0
  ds_read_b128 v[204:207], v78 offset:32
  ds_read_b128 v[208:211], v78 offset:64
  ds_read_b128 v[212:215], v78 offset:96
  ds_read_b128 v[216:219], v78 offset:128
  ds_read_b128 v[220:223], v78 offset:160
  ds_read_b128 v[224:227], v78 offset:192
  ds_read_b128 v[228:231], v78 offset:224
  s_waitcnt lgkmcnt(7)
  v_pk_fma_f32 v[104:105], v[200:201], v[70:71], v[104:105] op_sel_hi:[1,0,1]
  v_pk_fma_f32 v[106:107], v[202:203], v[70:71], v[106:107] op_sel_hi:[1,0,1]
  s_waitcnt lgkmcnt(6)
  v_pk_fma_f32 v[108:109], v[204:205], v[70:71], v[108:109] op_sel_hi:[1,0,1]
  v_pk_fma_f32 v[110:111], v[206:207], v[70:71], v[110:111] op_sel_hi:[1,0,1]
  v_pk_mul_f32 v[240:241], v[104:105], v[104:105]
  v_pk_mul_f32 v[242:243], v[106:107], v[106:107]
  v_pk_mul_f32 v[244:245], v[108:109], v[108:109]
  v_pk_mul_f32 v[246:247], v[110:111], v[110:111]
  v_pk_fma_f32 v[240:241], v[240:241], v[76:77], v[72:73] op_sel_hi:[1,0,0]
  v_pk_fma_f32 v[242:243], v[242:243], v[76:77], v[72:73] op_sel_hi:[1,0,0]
  v_pk_fma_f32 v[244:245], v[244:245], v[76:77], v[72:73] op_sel_hi:[1,0,0]
  s_add_u32 s59, s56, 262144
  s_add_u32 m0, s51, 114688
  s_nop 0
  buffer_load_dwordx4 v4, s[32:35], s59 offen offset:0 lds
  v_pk_fma_f32 v[246:247], v[246:247], v[76:77], v[72:73] op_sel_hi:[1,0,0]
  v_pk_mul_f32 v[240:241], v[240:241], v[104:105]
  v_pk_mul_f32 v[242:243], v[242:243], v[106:107]
  v_pk_mul_f32 v[244:245], v[244:245], v[108:109]
  v_pk_mul_f32 v[246:247], v[246:247], v[110:111]
  v_exp_f32 v240, v240
  v_exp_f32 v242, v242
  v_exp_f32 v244, v244
  v_exp_f32 v246, v246
  v_exp_f32 v241, v241
  v_exp_f32 v243, v243
  v_exp_f32 v245, v245
  v_exp_f32 v247, v247
  v_pk_fma_f32 v[240:241], v[240:241], v[68:69], v[68:69] op_sel_hi:[1,0,0]
  v_pk_fma_f32 v[242:243], v[242:243], v[68:69], v[68:69] op_sel_hi:[1,0,0]
  v_pk_fma_f32 v[244:245], v[244:245], v[68:69], v[68:69] op_sel_hi:[1,0,0]
  v_pk_fma_f32 v[246:247], v[246:247], v[68:69], v[68:69] op_sel_hi:[1,0,0]
  v_rcp_f32 v240, v240
  v_rcp_f32 v242, v242
  buffer_load_dwordx4 v5, s[32:35], s59 offen offset:1024 lds
  v_rcp_f32 v244, v244
  v_rcp_f32 v246, v246
  v_rcp_f32 v241, v241
  v_rcp_f32 v243, v243
  v_rcp_f32 v245, v245
  v_rcp_f32 v247, v247
  v_pk_mul_f32 v[240:241], v[240:241], v[104:105]
  v_pk_mul_f32 v[242:243], v[242:243], v[106:107]
  v_pk_mul_f32 v[244:245], v[244:245], v[108:109]
  v_pk_mul_f32 v[246:247], v[246:247], v[110:111]
  v_cvt_pk_bf16_f32 v232, v240, v241
  v_cvt_pk_bf16_f32 v233, v242, v243
  v_cvt_pk_bf16_f32 v234, v244, v245
  v_cvt_pk_bf16_f32 v235, v246, v247
  buffer_store_dwordx4 v[232:235], v2, s[44:47], s70 offen offset:0 sc1
  s_waitcnt lgkmcnt(5)
  v_pk_fma_f32 v[112:113], v[208:209], v[70:71], v[112:113] op_sel_hi:[1,0,1]
  v_pk_fma_f32 v[114:115], v[210:211], v[70:71], v[114:115] op_sel_hi:[1,0,1]
  s_waitcnt lgkmcnt(4)
  v_pk_fma_f32 v[116:117], v[212:213], v[70:71], v[116:117] op_sel_hi:[1,0,1]
  v_pk_fma_f32 v[118:119], v[214:215], v[70:71], v[118:119] op_sel_hi:[1,0,1]
  buffer_load_dwordx4 v6, s[32:35], s59 offen offset:2048 lds
  v_pk_mul_f32 v[240:241], v[112:113], v[112:113]
  v_pk_mul_f32 v[242:243], v[114:115], v[114:115]
  v_pk_mul_f32 v[244:245], v[116:117], v[116:117]
  v_pk_mul_f32 v[246:247], v[118:119], v[118:119]
  v_pk_fma_f32 v[240:241], v[240:241], v[76:77], v[72:73] op_sel_hi:[1,0,0]
  v_pk_fma_f32 v[242:243], v[242:243], v[76:77], v[72:73] op_sel_hi:[1,0,0]
  v_pk_fma_f32 v[244:245], v[244:245], v[76:77], v[72:73] op_sel_hi:[1,0,0]
  v_pk_fma_f32 v[246:247], v[246:247], v[76:77], v[72:73] op_sel_hi:[1,0,0]
  v_pk_mul_f32 v[240:241], v[240:241], v[112:113]
  v_pk_mul_f32 v[242:243], v[242:243], v[114:115]
  v_pk_mul_f32 v[244:245], v[244:245], v[116:117]
  v_pk_mul_f32 v[246:247], v[246:247], v[118:119]
  v_exp_f32 v240, v240
  v_exp_f32 v242, v242
  v_exp_f32 v244, v244
  v_exp_f32 v246, v246
  v_exp_f32 v241, v241
  v_exp_f32 v243, v243
  v_exp_f32 v245, v245
  buffer_load_dwordx4 v7, s[32:35], s59 offen offset:3072 lds
  v_exp_f32 v247, v247
  v_pk_fma_f32 v[240:241], v[240:241], v[68:69], v[68:69] op_sel_hi:[1,0,0]
  v_pk_fma_f32 v[242:243], v[242:243], v[68:69], v[68:69] op_sel_hi:[1,0,0]
  v_pk_fma_f32 v[244:245], v[244:245], v[68:69], v[68:69] op_sel_hi:[1,0,0]
  v_pk_fma_f32 v[246:247], v[246:247], v[68:69], v[68:69] op_sel_hi:[1,0,0]
  v_rcp_f32 v240, v240
  v_rcp_f32 v242, v242
  v_rcp_f32 v244, v244
  v_rcp_f32 v246, v246
  v_rcp_f32 v241, v241
  v_rcp_f32 v243, v243
  v_rcp_f32 v245, v245
  v_rcp_f32 v247, v247
  v_pk_mul_f32 v[240:241], v[240:241], v[112:113]
  v_pk_mul_f32 v[242:243], v[242:243], v[114:115]
  v_pk_mul_f32 v[244:245], v[244:245], v[116:117]
  v_pk_mul_f32 v[246:247], v[246:247], v[118:119]
  v_cvt_pk_bf16_f32 v236, v240, v241
  s_add_u32 s59, s56, 524288
  s_add_u32 m0, s51, 0
  s_nop 0
  buffer_load_dwordx4 v4, s[32:35], s59 offen offset:0 lds
  v_cvt_pk_bf16_f32 v237, v242, v243
  v_cvt_pk_bf16_f32 v238, v244, v245
  v_cvt_pk_bf16_f32 v239, v246, v247
  buffer_store_dwordx4 v[236:239], v2, s[44:47], s70 offen offset:1024 sc1
  s_waitcnt lgkmcnt(3)
  v_pk_fma_f32 v[120:121], v[216:217], v[70:71], v[120:121] op_sel_hi:[1,0,1]
  v_pk_fma_f32 v[122:123], v[218:219], v[70:71], v[122:123] op_sel_hi:[1,0,1]
  s_waitcnt lgkmcnt(2)
  v_pk_fma_f32 v[124:125], v[220:221], v[70:71], v[124:125] op_sel_hi:[1,0,1]
  v_pk_fma_f32 v[126:127], v[222:223], v[70:71], v[126:127] op_sel_hi:[1,0,1]
  v_pk_mul_f32 v[240:241], v[120:121], v[120:121]
  v_pk_mul_f32 v[242:243], v[122:123], v[122:123]
  v_pk_mul_f32 v[244:245], v[124:125], v[124:125]
  v_pk_mul_f32 v[246:247], v[126:127], v[126:127]
  v_pk_fma_f32 v[240:241], v[240:241], v[76:77], v[72:73] op_sel_hi:[1,0,0]
  v_pk_fma_f32 v[242:243], v[242:243], v[76:77], v[72:73] op_sel_hi:[1,0,0]
  v_pk_fma_f32 v[244:245], v[244:245], v[76:77], v[72:73] op_sel_hi:[1,0,0]
  v_pk_fma_f32 v[246:247], v[246:247], v[76:77], v[72:73] op_sel_hi:[1,0,0]
  v_pk_mul_f32 v[240:241], v[240:241], v[120:121]
  v_pk_mul_f32 v[242:243], v[242:243], v[122:123]
  v_pk_mul_f32 v[244:245], v[244:245], v[124:125]
  buffer_load_dwordx4 v5, s[32:35], s59 offen offset:1024 lds
  v_pk_mul_f32 v[246:247], v[246:247], v[126:127]
  v_exp_f32 v240, v240
  v_exp_f32 v242, v242
  v_exp_f32 v244, v244
  v_exp_f32 v246, v246
  v_exp_f32 v241, v241
  v_exp_f32 v243, v243
  v_exp_f32 v245, v245
  v_exp_f32 v247, v247
  v_pk_fma_f32 v[240:241], v[240:241], v[68:69], v[68:69] op_sel_hi:[1,0,0]
  v_pk_fma_f32 v[242:243], v[242:243], v[68:69], v[68:69] op_sel_hi:[1,0,0]
  v_pk_fma_f32 v[244:245], v[244:245], v[68:69], v[68:69] op_sel_hi:[1,0,0]
  v_pk_fma_f32 v[246:247], v[246:247], v[68:69], v[68:69] op_sel_hi:[1,0,0]
  v_rcp_f32 v240, v240
  v_rcp_f32 v242, v242
  v_rcp_f32 v244, v244
  v_rcp_f32 v246, v246
  v_rcp_f32 v241, v241
  v_rcp_f32 v243, v243
  buffer_load_dwordx4 v6, s[32:35], s59 offen offset:2048 lds
  v_rcp_f32 v245, v245
  v_rcp_f32 v247, v247
  v_pk_mul_f32 v[240:241], v[240:241], v[120:121]
  v_pk_mul_f32 v[242:243], v[242:243], v[122:123]
  v_pk_mul_f32 v[244:245], v[244:245], v[124:125]
  v_pk_mul_f32 v[246:247], v[246:247], v[126:127]
  v_cvt_pk_bf16_f32 v232, v240, v241
  v_cvt_pk_bf16_f32 v233, v242, v243
  v_cvt_pk_bf16_f32 v234, v244, v245
  v_cvt_pk_bf16_f32 v235, v246, v247
  buffer_store_dwordx4 v[232:235], v2, s[44:47], s70 offen offset:2048 sc1
  s_waitcnt lgkmcnt(1)
  v_pk_fma_f32 v[128:129], v[224:225], v[70:71], v[128:129] op_sel_hi:[1,0,1]
  v_pk_fma_f32 v[130:131], v[226:227], v[70:71], v[130:131] op_sel_hi:[1,0,1]
  s_waitcnt lgkmcnt(0)
  v_pk_fma_f32 v[132:133], v[228:229], v[70:71], v[132:133] op_sel_hi:[1,0,1]
  v_pk_fma_f32 v[134:135], v[230:231], v[70:71], v[134:135] op_sel_hi:[1,0,1]
  v_pk_mul_f32 v[240:241], v[128:129], v[128:129]
  v_pk_mul_f32 v[242:243], v[130:131], v[130:131]
  v_pk_mul_f32 v[244:245], v[132:133], v[132:133]
  v_pk_mul_f32 v[246:247], v[134:135], v[134:135]
  buffer_load_dwordx4 v7, s[32:35], s59 offen offset:3072 lds
  v_pk_fma_f32 v[240:241], v[240:241], v[76:77], v[72:73] op_sel_hi:[1,0,0]
  v_pk_fma_f32 v[242:243], v[242:243], v[76:77], v[72:73] op_sel_hi:[1,0,0]
  v_pk_fma_f32 v[244:245], v[244:245], v[76:77], v[72:73] op_sel_hi:[1,0,0]
  v_pk_fma_f32 v[246:247], v[246:247], v[76:77], v[72:73] op_sel_hi:[1,0,0]
  v_pk_mul_f32 v[240:241], v[240:241], v[128:129]
  v_pk_mul_f32 v[242:243], v[242:243], v[130:131]
  v_pk_mul_f32 v[244:245], v[244:245], v[132:133]
  v_pk_mul_f32 v[246:247], v[246:247], v[134:135]
  v_exp_f32 v240, v240
  v_exp_f32 v242, v242
  v_exp_f32 v244, v244
  v_exp_f32 v246, v246
  v_exp_f32 v241, v241
  v_exp_f32 v243, v243
  v_exp_f32 v245, v245
  v_exp_f32 v247, v247
  v_pk_fma_f32 v[240:241], v[240:241], v[68:69], v[68:69] op_sel_hi:[1,0,0]
  v_pk_fma_f32 v[242:243], v[242:243], v[68:69], v[68:69] op_sel_hi:[1,0,0]
  v_pk_fma_f32 v[244:245], v[244:245], v[68:69], v[68:69] op_sel_hi:[1,0,0]
  s_add_u32 s59, s56, 786432
  s_add_u32 m0, s51, 65536
  s_nop 0
  buffer_load_dwordx4 v4, s[32:35], s59 offen offset:0 lds
  v_pk_fma_f32 v[246:247], v[246:247], v[68:69], v[68:69] op_sel_hi:[1,0,0]
  v_rcp_f32 v240, v240
  v_rcp_f32 v242, v242
  v_rcp_f32 v244, v244
  v_rcp_f32 v246, v246
  v_rcp_f32 v241, v241
  v_rcp_f32 v243, v243
  v_rcp_f32 v245, v245
  v_rcp_f32 v247, v247
  v_pk_mul_f32 v[240:241], v[240:241], v[128:129]
  v_pk_mul_f32 v[242:243], v[242:243], v[130:131]
  v_pk_mul_f32 v[244:245], v[244:245], v[132:133]
  v_pk_mul_f32 v[246:247], v[246:247], v[134:135]
  v_cvt_pk_bf16_f32 v236, v240, v241
  v_cvt_pk_bf16_f32 v237, v242, v243
  v_cvt_pk_bf16_f32 v238, v244, v245
  v_cvt_pk_bf16_f32 v239, v246, v247
  buffer_store_dwordx4 v[236:239], v2, s[44:47], s70 offen offset:3072 sc1
  buffer_load_dwordx4 v5, s[32:35], s59 offen offset:1024 lds
  s_add_u32 s70, s70, 4096
  v_and_b32 v36, 15, v1
  v_min_u32 v36, 13, v36
  s_lshl_b32 s60, s73, 7
  s_add_u32 s60, s60, 18169856
  v_lshl_add_u32 v36, v36, 2, s60
  ds_read_b64_tr_b16 v[80:81], v24 offset:0
  ds_read_b64_tr_b16 v[82:83], v24 offset:1024
  ds_read_b64_tr_b16 v[84:85], v27 offset:0
  ds_read_b64_tr_b16 v[86:87], v27 offset:1024
  ds_read_b64_tr_b16 v[88:89], v24 offset:2048
  ds_read_b64_tr_b16 v[90:91], v24 offset:3072
  ds_read_b64_tr_b16 v[92:93], v27 offset:2048
  ds_read_b64_tr_b16 v[94:95], v27 offset:3072
  ds_read_b64_tr_b16 v[96:97], v24 offset:4096
  ds_read_b64_tr_b16 v[98:99], v24 offset:5120
  s_waitcnt lgkmcnt(8)
  v_mfma_f32_32x32x16_bf16 v[136:151], v[80:83], a[128:131], 0
  ds_read_b64_tr_b16 v[100:101], v27 offset:4096
  ds_read_b64_tr_b16 v[102:103], v27 offset:5120
  s_waitcnt lgkmcnt(8)
  v_mfma_f32_32x32x16_bf16 v[152:167], v[84:87], a[128:131], 0
  buffer_load_dwordx4 v6, s[32:35], s59 offen offset:2048 lds
  ds_read_b64_tr_b16 v[80:81], v24 offset:6144
  ds_read_b64_tr_b16 v[82:83], v24 offset:7168
  s_waitcnt lgkmcnt(8)
  v_mfma_f32_32x32x16_bf16 v[136:151], v[88:91], a[132:135], v[136:151]
  ds_read_b64_tr_b16 v[84:85], v27 offset:6144
  ds_read_b64_tr_b16 v[86:87], v27 offset:7168
  s_waitcnt lgkmcnt(8)
  v_mfma_f32_32x32x16_bf16 v[152:167], v[92:95], a[132:135], v[152:167]
  buffer_load_dwordx4 v7, s[32:35], s59 offen offset:3072 lds
  ds_read_b64_tr_b16 v[88:89], v24 offset:8192
  ds_read_b64_tr_b16 v[90:91], v24 offset:9216
  s_waitcnt lgkmcnt(8)
  v_mfma_f32_32x32x16_bf16 v[136:151], v[96:99], a[136:139], v[136:151]
  s_waitcnt vmcnt(18)
  v_add_f32 v184, v184, v188
  s_waitcnt vmcnt(16)
  v_add_f32 v192, v192, v196
  ds_read_b64_tr_b16 v[92:93], v27 offset:8192
  ds_read_b64_tr_b16 v[94:95], v27 offset:9216
  s_waitcnt lgkmcnt(8)
  v_mfma_f32_32x32x16_bf16 v[152:167], v[100:103], a[136:139], v[152:167]
  s_add_u32 s59, s56, 1048576
  s_add_u32 m0, s51, 16384
  s_nop 0
  buffer_load_dwordx4 v4, s[32:35], s59 offen offset:0 lds
  v_add_f32 v185, v185, v189
  v_add_f32 v193, v193, v197
  ds_read_b64_tr_b16 v[96:97], v24 offset:10240
  ds_read_b64_tr_b16 v[98:99], v24 offset:11264
  s_waitcnt lgkmcnt(8)
  v_mfma_f32_32x32x16_bf16 v[136:151], v[80:83], a[140:143], v[136:151]
  v_add_f32 v186, v186, v190
  v_add_f32 v194, v194, v198
  ds_read_b64_tr_b16 v[100:101], v27 offset:10240
  ds_read_b64_tr_b16 v[102:103], v27 offset:11264
  s_waitcnt lgkmcnt(8)
  v_mfma_f32_32x32x16_bf16 v[152:167], v[84:87], a[140:143], v[152:167]
  buffer_load_dwordx4 v5, s[32:35], s59 offen offset:1024 lds
  v_add_f32 v187, v187, v191
  v_add_f32 v195, v195, v199
  ds_read_b64_tr_b16 v[80:81], v24 offset:12288
  ds_read_b64_tr_b16 v[82:83], v24 offset:13312
  s_waitcnt lgkmcnt(8)
  v_mfma_f32_32x32x16_bf16 v[136:151], v[88:91], a[144:147], v[136:151]
  v_add_f32 v184, v184, v192
  v_add_f32 v185, v185, v193
  ds_read_b64_tr_b16 v[84:85], v27 offset:12288
  ds_read_b64_tr_b16 v[86:87], v27 offset:13312
  s_waitcnt lgkmcnt(8)
  v_mfma_f32_32x32x16_bf16 v[152:167], v[92:95], a[144:147], v[152:167]
  buffer_load_dwordx4 v6, s[32:35], s59 offen offset:2048 lds
  v_add_f32 v186, v186, v194
  v_add_f32 v187, v187, v195
  ds_read_b64_tr_b16 v[88:89], v24 offset:14336
  ds_read_b64_tr_b16 v[90:91], v24 offset:15360
  s_waitcnt lgkmcnt(8)
  v_mfma_f32_32x32x16_bf16 v[136:151], v[96:99], a[148:151], v[136:151]
  v_cmp_gt_u32 s[74:75], 8, v1
  v_mov_b32 v192, 0x80000000
  ds_read_b64_tr_b16 v[92:93], v27 offset:14336
  ds_read_b64_tr_b16 v[94:95], v27 offset:15360
  s_waitcnt lgkmcnt(8)
  v_mfma_f32_32x32x16_bf16 v[152:167], v[100:103], a[148:151], v[152:167]
  buffer_load_dwordx4 v7, s[32:35], s59 offen offset:3072 lds
  v_add_f32_dpp v188, v184, v184 row_ror:8 row_mask:0xf bank_mask:0xf
  v_add_f32_dpp v189, v185, v185 row_ror:8 row_mask:0xf bank_mask:0xf
  ds_read_b64_tr_b16 v[96:97], v23 offset:16384
  ds_read_b64_tr_b16 v[98:99], v23 offset:17408
  s_waitcnt lgkmcnt(8)
  v_mfma_f32_32x32x16_bf16 v[136:151], v[80:83], a[152:155], v[136:151]
  v_add_f32_dpp v190, v186, v186 row_ror:8 row_mask:0xf bank_mask:0xf
  v_add_f32_dpp v191, v187, v187 row_ror:8 row_mask:0xf bank_mask:0xf
  ds_read_b64_tr_b16 v[100:101], v26 offset:16384
  ds_read_b64_tr_b16 v[102:103], v26 offset:17408
  s_waitcnt lgkmcnt(8)
  v_mfma_f32_32x32x16_bf16 v[152:167], v[84:87], a[152:155], v[152:167]
  v_cndmask_b32 v192, v192, v2, s[74:75]
  v_mov_b32 v184, v188
  ds_read_b64_tr_b16 v[80:81], v23 offset:18432
  ds_read_b64_tr_b16 v[82:83], v23 offset:19456
  s_waitcnt lgkmcnt(8)
  v_mfma_f32_32x32x16_bf16 v[136:151], v[88:91], a[156:159], v[136:151]
  v_mov_b32 v185, v189
  v_mov_b32 v186, v190
  ds_read_b64_tr_b16 v[84:85], v26 offset:18432
  ds_read_b64_tr_b16 v[86:87], v26 offset:19456
  s_waitcnt lgkmcnt(8)
  v_mfma_f32_32x32x16_bf16 v[152:167], v[92:95], a[156:159], v[152:167]
  v_mov_b32 v187, v191
  v_permlane16_swap_b32 v184, v188
  ds_read_b64_tr_b16 v[88:89], v23 offset:20480
  ds_read_b64_tr_b16 v[90:91], v23 offset:21504
  s_waitcnt lgkmcnt(8)
  v_mfma_f32_32x32x16_bf16 v[136:151], v[96:99], a[160:163], v[136:151]
  s_lshl_b32 s60, s64, 5
  s_add_u32 s60, s60, s65
  s_lshl_b32 s60, s60, 2
  s_add_u32 s60, s60, 18169856
  s_waitcnt vmcnt(7)
  buffer_store_dword v3, v34, s[44:47], s60 offen sc1
  v_permlane16_swap_b32 v185, v189
  v_permlane16_swap_b32 v186, v190
  ds_read_b64_tr_b16 v[92:93], v26 offset:20480
  ds_read_b64_tr_b16 v[94:95], v26 offset:21504
  s_waitcnt lgkmcnt(8)
  v_mfma_f32_32x32x16_bf16 v[152:167], v[100:103], a[160:163], v[152:167]
  v_permlane16_swap_b32 v187, v191
  v_add_f32 v188, v184, v188
  ds_read_b64_tr_b16 v[96:97], v23 offset:22528
  ds_read_b64_tr_b16 v[98:99], v23 offset:23552
  s_waitcnt lgkmcnt(8)
  v_mfma_f32_32x32x16_bf16 v[136:151], v[80:83], a[164:167], v[136:151]
  v_add_f32 v189, v185, v189
  v_add_f32 v190, v186, v190
  ds_read_b64_tr_b16 v[100:101], v26 offset:22528
  ds_read_b64_tr_b16 v[102:103], v26 offset:23552
  s_waitcnt lgkmcnt(8)
  v_mfma_f32_32x32x16_bf16 v[152:167], v[84:87], a[164:167], v[152:167]
  v_add_f32 v191, v187, v191
  v_mov_b32 v184, v188
  ds_read_b64_tr_b16 v[80:81], v23 offset:24576
  ds_read_b64_tr_b16 v[82:83], v23 offset:25600
  s_waitcnt lgkmcnt(8)
  v_mfma_f32_32x32x16_bf16 v[136:151], v[88:91], a[168:171], v[136:151]
  v_mov_b32 v185, v189
  v_mov_b32 v186, v190
  ds_read_b64_tr_b16 v[84:85], v26 offset:24576
  ds_read_b64_tr_b16 v[86:87], v26 offset:25600
  s_waitcnt lgkmcnt(8)
  v_mfma_f32_32x32x16_bf16 v[152:167], v[92:95], a[168:171], v[152:167]
  v_mov_b32 v187, v191
  v_permlane32_swap_b32 v184, v188
  ds_read_b64_tr_b16 v[88:89], v23 offset:26624
  ds_read_b64_tr_b16 v[90:91], v23 offset:27648
  s_waitcnt lgkmcnt(8)
  v_mfma_f32_32x32x16_bf16 v[136:151], v[96:99], a[172:175], v[136:151]
  v_permlane32_swap_b32 v185, v189
  v_permlane32_swap_b32 v186, v190
  ds_read_b64_tr_b16 v[92:93], v26 offset:26624
  ds_read_b64_tr_b16 v[94:95], v26 offset:27648
  s_waitcnt lgkmcnt(8)
  v_mfma_f32_32x32x16_bf16 v[152:167], v[100:103], a[172:175], v[152:167]
  v_permlane32_swap_b32 v187, v191
  v_add_f32 v188, v184, v188
  ds_read_b64_tr_b16 v[96:97], v23 offset:28672
  ds_read_b64_tr_b16 v[98:99], v23 offset:29696
  s_waitcnt lgkmcnt(8)
  v_mfma_f32_32x32x16_bf16 v[136:151], v[80:83], a[176:179], v[136:151]
  v_add_f32 v189, v185, v189
  v_add_f32 v190, v186, v190
  ds_read_b64_tr_b16 v[100:101], v26 offset:28672
  ds_read_b64_tr_b16 v[102:103], v26 offset:29696
  s_waitcnt lgkmcnt(8)
  v_mfma_f32_32x32x16_bf16 v[152:167], v[84:87], a[176:179], v[152:167]
  v_add_f32 v191, v187, v191
  v_cvt_pk_bf16_f32 v184, v188, v189
  ds_read_b64_tr_b16 v[80:81], v23 offset:30720
  ds_read_b64_tr_b16 v[82:83], v23 offset:31744
  s_waitcnt lgkmcnt(8)
  v_mfma_f32_32x32x16_bf16 v[136:151], v[88:91], a[180:183], v[136:151]
  v_cvt_pk_bf16_f32 v185, v190, v191
  s_lshr_b32 s61, s48, 2
  s_lshl3_add_u32 s60, s49, s61
  s_and_b32 s61, s48, 1
  s_lshl1_add_u32 s60, s60, s61
  s_lshl2_add_u32 s60, s60, s50
  s_lshl_b32 s60, s60, 7
  s_and_b32 s61, s48, 2
  s_lshl2_add_u32 s60, s61, s60
  s_add_u32 s60, s60, 17825792
  buffer_store_dwordx2 v[184:185], v192, s[40:43], s60 offen sc1
  ds_read_b64_tr_b16 v[84:85], v26 offset:30720
  ds_read_b64_tr_b16 v[86:87], v26 offset:31744
  s_waitcnt lgkmcnt(8)
  v_mfma_f32_32x32x16_bf16 v[152:167], v[92:95], a[180:183], v[152:167]
  ds_read_b64_tr_b16 v[88:89], v22 offset:32768
  ds_read_b64_tr_b16 v[90:91], v22 offset:33792
  s_waitcnt lgkmcnt(8)
  v_mfma_f32_32x32x16_bf16 v[136:151], v[96:99], a[184:187], v[136:151]
  ds_read_b64_tr_b16 v[92:93], v25 offset:32768
  ds_read_b64_tr_b16 v[94:95], v25 offset:33792
  s_waitcnt lgkmcnt(8)
  v_mfma_f32_32x32x16_bf16 v[152:167], v[100:103], a[184:187], v[152:167]
  ds_read_b64_tr_b16 v[96:97], v22 offset:34816
  ds_read_b64_tr_b16 v[98:99], v22 offset:35840
  s_waitcnt lgkmcnt(8)
  v_mfma_f32_32x32x16_bf16 v[136:151], v[80:83], a[188:191], v[136:151]
  ds_read_b64_tr_b16 v[100:101], v25 offset:34816
  ds_read_b64_tr_b16 v[102:103], v25 offset:35840
  s_waitcnt lgkmcnt(8)
  v_mfma_f32_32x32x16_bf16 v[152:167], v[84:87], a[188:191], v[152:167]
  ds_read_b64_tr_b16 v[80:81], v22 offset:36864
  ds_read_b64_tr_b16 v[82:83], v22 offset:37888
  s_waitcnt lgkmcnt(8)
  v_mfma_f32_32x32x16_bf16 v[136:151], v[88:91], a[192:195], v[136:151]
  ds_read_b64_tr_b16 v[84:85], v25 offset:36864
  ds_read_b64_tr_b16 v[86:87], v25 offset:37888
  s_waitcnt lgkmcnt(8)
  v_mfma_f32_32x32x16_bf16 v[152:167], v[92:95], a[192:195], v[152:167]
  ds_read_b64_tr_b16 v[88:89], v22 offset:38912
  ds_read_b64_tr_b16 v[90:91], v22 offset:39936
  s_waitcnt lgkmcnt(8)
  v_mfma_f32_32x32x16_bf16 v[136:151], v[96:99], a[196:199], v[136:151]
  ds_read_b64_tr_b16 v[92:93], v25 offset:38912
  ds_read_b64_tr_b16 v[94:95], v25 offset:39936
  s_waitcnt lgkmcnt(8)
  v_mfma_f32_32x32x16_bf16 v[152:167], v[100:103], a[196:199], v[152:167]
  ds_read_b64_tr_b16 v[96:97], v22 offset:40960
  ds_read_b64_tr_b16 v[98:99], v22 offset:41984
  s_waitcnt lgkmcnt(8)
  v_mfma_f32_32x32x16_bf16 v[136:151], v[80:83], a[200:203], v[136:151]
  ds_read_b64_tr_b16 v[100:101], v25 offset:40960
  ds_read_b64_tr_b16 v[102:103], v25 offset:41984
  s_waitcnt lgkmcnt(8)
  v_mfma_f32_32x32x16_bf16 v[152:167], v[84:87], a[200:203], v[152:167]
  ds_read_b64_tr_b16 v[80:81], v22 offset:43008
  ds_read_b64_tr_b16 v[82:83], v22 offset:44032
  s_waitcnt lgkmcnt(8)
  v_mfma_f32_32x32x16_bf16 v[136:151], v[88:91], a[204:207], v[136:151]
  ds_read_b64_tr_b16 v[84:85], v25 offset:43008
  ds_read_b64_tr_b16 v[86:87], v25 offset:44032
  s_waitcnt lgkmcnt(8)
  v_mfma_f32_32x32x16_bf16 v[152:167], v[92:95], a[204:207], v[152:167]
  ds_read_b64_tr_b16 v[88:89], v22 offset:45056
  ds_read_b64_tr_b16 v[90:91], v22 offset:46080
  s_waitcnt lgkmcnt(8)
  v_mfma_f32_32x32x16_bf16 v[136:151], v[96:99], a[208:211], v[136:151]
  ds_read_b64_tr_b16 v[92:93], v25 offset:45056
  ds_read_b64_tr_b16 v[94:95], v25 offset:46080
  s_waitcnt lgkmcnt(8)
  v_mfma_f32_32x32x16_bf16 v[152:167], v[100:103], a[208:211], v[152:167]
  ds_read_b64_tr_b16 v[96:97], v22 offset:47104
  ds_read_b64_tr_b16 v[98:99], v22 offset:48128
  s_waitcnt lgkmcnt(8)
  v_mfma_f32_32x32x16_bf16 v[136:151], v[80:83], a[212:215], v[136:151]
  ds_read_b64_tr_b16 v[100:101], v25 offset:47104
  ds_read_b64_tr_b16 v[102:103], v25 offset:48128
  s_waitcnt lgkmcnt(8)
  v_mfma_f32_32x32x16_bf16 v[152:167], v[84:87], a[212:215], v[152:167]
  ds_read_b64_tr_b16 v[80:81], v23 offset:32768
  ds_read_b64_tr_b16 v[82:83], v23 offset:33792
  s_waitcnt lgkmcnt(8)
  v_mfma_f32_32x32x16_bf16 v[136:151], v[88:91], a[216:219], v[136:151]
  ds_read_b64_tr_b16 v[84:85], v26 offset:32768
  ds_read_b64_tr_b16 v[86:87], v26 offset:33792
  s_waitcnt lgkmcnt(8)
  v_mfma_f32_32x32x16_bf16 v[152:167], v[92:95], a[216:219], v[152:167]
  ds_read_b64_tr_b16 v[88:89], v23 offset:34816
  ds_read_b64_tr_b16 v[90:91], v23 offset:35840
  s_waitcnt lgkmcnt(8)
  v_mfma_f32_32x32x16_bf16 v[136:151], v[96:99], a[220:223], v[136:151]
  ds_read_b64_tr_b16 v[92:93], v26 offset:34816
  ds_read_b64_tr_b16 v[94:95], v26 offset:35840
  s_waitcnt lgkmcnt(8)
  v_mfma_f32_32x32x16_bf16 v[152:167], v[100:103], a[220:223], v[152:167]
  ds_read_b64_tr_b16 v[96:97], v23 offset:36864
  ds_read_b64_tr_b16 v[98:99], v23 offset:37888
  s_waitcnt lgkmcnt(8)
  v_mfma_f32_32x32x16_bf16 v[136:151], v[80:83], a[224:227], v[136:151]
  s_lshl_b32 s60, s49, 5
  s_add_u32 s60, s60, s48
  s_lshl2_add_u32 s60, s60, s50
  s_lshl_b32 s60, s60, 2
  s_add_u32 s60, s60, 18198528
  s_waitcnt vmcnt(0)
  buffer_store_dword v3, v34, s[40:43], s60 offen sc1
  ds_read_b64_tr_b16 v[100:101], v26 offset:36864
  ds_read_b64_tr_b16 v[102:103], v26 offset:37888
  s_waitcnt lgkmcnt(8)
  v_mfma_f32_32x32x16_bf16 v[152:167], v[84:87], a[224:227], v[152:167]
  ds_read_b64_tr_b16 v[80:81], v23 offset:38912
  ds_read_b64_tr_b16 v[82:83], v23 offset:39936
  s_waitcnt lgkmcnt(8)
  v_mfma_f32_32x32x16_bf16 v[136:151], v[88:91], a[228:231], v[136:151]
  ds_read_b64_tr_b16 v[84:85], v26 offset:38912
  ds_read_b64_tr_b16 v[86:87], v26 offset:39936
  s_waitcnt lgkmcnt(8)
  v_mfma_f32_32x32x16_bf16 v[152:167], v[92:95], a[228:231], v[152:167]
  ds_read_b64_tr_b16 v[88:89], v23 offset:40960
  ds_read_b64_tr_b16 v[90:91], v23 offset:41984
  s_waitcnt lgkmcnt(8)
  v_mfma_f32_32x32x16_bf16 v[136:151], v[96:99], a[232:235], v[136:151]
  ds_read_b64_tr_b16 v[92:93], v26 offset:40960
  ds_read_b64_tr_b16 v[94:95], v26 offset:41984
  s_waitcnt lgkmcnt(8)
  v_mfma_f32_32x32x16_bf16 v[152:167], v[100:103], a[232:235], v[152:167]
  ds_read_b64_tr_b16 v[96:97], v23 offset:43008
  ds_read_b64_tr_b16 v[98:99], v23 offset:44032
  s_waitcnt lgkmcnt(8)
  v_mfma_f32_32x32x16_bf16 v[136:151], v[80:83], a[236:239], v[136:151]
  ds_read_b64_tr_b16 v[100:101], v26 offset:43008
  ds_read_b64_tr_b16 v[102:103], v26 offset:44032
  s_waitcnt lgkmcnt(8)
  v_mfma_f32_32x32x16_bf16 v[152:167], v[84:87], a[236:239], v[152:167]
  ds_read_b64_tr_b16 v[80:81], v23 offset:45056
  ds_read_b64_tr_b16 v[82:83], v23 offset:46080
  s_waitcnt lgkmcnt(8)
  v_mfma_f32_32x32x16_bf16 v[136:151], v[88:91], a[240:243], v[136:151]
  ds_read_b64_tr_b16 v[84:85], v26 offset:45056
  ds_read_b64_tr_b16 v[86:87], v26 offset:46080
  s_waitcnt lgkmcnt(8)
  v_mfma_f32_32x32x16_bf16 v[152:167], v[92:95], a[240:243], v[152:167]
  ds_read_b64_tr_b16 v[88:89], v23 offset:47104
  ds_read_b64_tr_b16 v[90:91], v23 offset:48128
  s_waitcnt lgkmcnt(8)
  v_mfma_f32_32x32x16_bf16 v[136:151], v[96:99], a[244:247], v[136:151]
  ds_read_b64_tr_b16 v[92:93], v26 offset:47104
  ds_read_b64_tr_b16 v[94:95], v26 offset:48128
  s_waitcnt lgkmcnt(8)
  v_mfma_f32_32x32x16_bf16 v[152:167], v[100:103], a[244:247], v[152:167]
  s_waitcnt lgkmcnt(6)
  v_mfma_f32_32x32x16_bf16 v[136:151], v[80:83], a[248:251], v[136:151]
  s_waitcnt lgkmcnt(4)
  v_mfma_f32_32x32x16_bf16 v[152:167], v[84:87], a[248:251], v[152:167]
  s_waitcnt lgkmcnt(2)
  v_mfma_f32_32x32x16_bf16 v[136:151], v[88:91], a[252:255], v[136:151]
  s_waitcnt lgkmcnt(0)
  v_mfma_f32_32x32x16_bf16 v[152:167], v[92:95], a[252:255], v[152:167]
  s_barrier
  ds_read_b128 v[200:203], v78 offset:256
  ds_read_b128 v[204:207], v78 offset:288
  ds_read_b128 v[208:211], v78 offset:320
  ds_read_b128 v[212:215], v78 offset:352
  ds_read_b128 v[216:219], v78 offset:384
  ds_read_b128 v[220:223], v78 offset:416
  ds_read_b128 v[224:227], v78 offset:448
  ds_read_b128 v[228:231], v78 offset:480
  s_waitcnt lgkmcnt(7)
  v_pk_fma_f32 v[136:137], v[200:201], v[70:71], v[136:137] op_sel_hi:[1,0,1]
  v_pk_fma_f32 v[138:139], v[202:203], v[70:71], v[138:139] op_sel_hi:[1,0,1]
  s_waitcnt lgkmcnt(6)
  v_pk_fma_f32 v[140:141], v[204:205], v[70:71], v[140:141] op_sel_hi:[1,0,1]
  v_pk_fma_f32 v[142:143], v[206:207], v[70:71], v[142:143] op_sel_hi:[1,0,1]
  s_add_u32 s59, s56, 1310720
  s_add_u32 m0, s51, 131072
  s_nop 0
  buffer_load_dwordx4 v4, s[32:35], s59 offen offset:0 lds
  v_pk_mul_f32 v[240:241], v[136:137], v[136:137]
  v_pk_mul_f32 v[242:243], v[138:139], v[138:139]
  v_pk_mul_f32 v[244:245], v[140:141], v[140:141]
  v_pk_mul_f32 v[246:247], v[142:143], v[142:143]
  v_pk_fma_f32 v[240:241], v[240:241], v[76:77], v[72:73] op_sel_hi:[1,0,0]
  v_pk_fma_f32 v[242:243], v[242:243], v[76:77], v[72:73] op_sel_hi:[1,0,0]
  v_pk_fma_f32 v[244:245], v[244:245], v[76:77], v[72:73] op_sel_hi:[1,0,0]
  v_pk_fma_f32 v[246:247], v[246:247], v[76:77], v[72:73] op_sel_hi:[1,0,0]
  v_pk_mul_f32 v[240:241], v[240:241], v[136:137]
  v_pk_mul_f32 v[242:243], v[242:243], v[138:139]
  v_pk_mul_f32 v[244:245], v[244:245], v[140:141]
  v_pk_mul_f32 v[246:247], v[246:247], v[142:143]
  buffer_load_dwordx4 v5, s[32:35], s59 offen offset:1024 lds
  v_exp_f32 v240, v240
  v_exp_f32 v242, v242
  v_exp_f32 v244, v244
  v_exp_f32 v246, v246
  v_exp_f32 v241, v241
  v_exp_f32 v243, v243
  v_exp_f32 v245, v245
  v_exp_f32 v247, v247
  v_pk_fma_f32 v[240:241], v[240:241], v[68:69], v[68:69] op_sel_hi:[1,0,0]
  v_pk_fma_f32 v[242:243], v[242:243], v[68:69], v[68:69] op_sel_hi:[1,0,0]
  v_pk_fma_f32 v[244:245], v[244:245], v[68:69], v[68:69] op_sel_hi:[1,0,0]
  v_pk_fma_f32 v[246:247], v[246:247], v[68:69], v[68:69] op_sel_hi:[1,0,0]
  buffer_load_dwordx4 v6, s[32:35], s59 offen offset:2048 lds
  v_rcp_f32 v240, v240
  v_rcp_f32 v242, v242
  v_rcp_f32 v244, v244
  v_rcp_f32 v246, v246
  v_rcp_f32 v241, v241
  v_rcp_f32 v243, v243
  v_rcp_f32 v245, v245
  v_rcp_f32 v247, v247
  v_pk_mul_f32 v[240:241], v[240:241], v[136:137]
  v_pk_mul_f32 v[242:243], v[242:243], v[138:139]
  v_pk_mul_f32 v[244:245], v[244:245], v[140:141]
  buffer_load_dwordx4 v7, s[32:35], s59 offen offset:3072 lds
  v_pk_mul_f32 v[246:247], v[246:247], v[142:143]
  v_cvt_pk_bf16_f32 v232, v240, v241
  v_cvt_pk_bf16_f32 v233, v242, v243
  v_cvt_pk_bf16_f32 v234, v244, v245
  v_cvt_pk_bf16_f32 v235, v246, v247
  buffer_store_dwordx4 v[232:235], v2, s[44:47], s70 offen offset:0 sc1
  s_waitcnt lgkmcnt(5)
  v_pk_fma_f32 v[144:145], v[208:209], v[70:71], v[144:145] op_sel_hi:[1,0,1]
  v_pk_fma_f32 v[146:147], v[210:211], v[70:71], v[146:147] op_sel_hi:[1,0,1]
  s_waitcnt lgkmcnt(4)
  v_pk_fma_f32 v[148:149], v[212:213], v[70:71], v[148:149] op_sel_hi:[1,0,1]
  v_pk_fma_f32 v[150:151], v[214:215], v[70:71], v[150:151] op_sel_hi:[1,0,1]
  v_pk_mul_f32 v[240:241], v[144:145], v[144:145]
  v_pk_mul_f32 v[242:243], v[146:147], v[146:147]
  s_add_u32 s59, s56, 1572864
  s_add_u32 m0, s51, 81920
  s_nop 0
  buffer_load_dwordx4 v4, s[32:35], s59 offen offset:0 lds
  v_pk_mul_f32 v[244:245], v[148:149], v[148:149]
  v_pk_mul_f32 v[246:247], v[150:151], v[150:151]
  v_pk_fma_f32 v[240:241], v[240:241], v[76:77], v[72:73] op_sel_hi:[1,0,0]
  v_pk_fma_f32 v[242:243], v[242:243], v[76:77], v[72:73] op_sel_hi:[1,0,0]
  v_pk_fma_f32 v[244:245], v[244:245], v[76:77], v[72:73] op_sel_hi:[1,0,0]
  v_pk_fma_f32 v[246:247], v[246:247], v[76:77], v[72:73] op_sel_hi:[1,0,0]
  v_pk_mul_f32 v[240:241], v[240:241], v[144:145]
  v_pk_mul_f32 v[242:243], v[242:243], v[146:147]
  v_pk_mul_f32 v[244:245], v[244:245], v[148:149]
  v_pk_mul_f32 v[246:247], v[246:247], v[150:151]
  v_exp_f32 v240, v240
  v_exp_f32 v242, v242
  buffer_load_dwordx4 v5, s[32:35], s59 offen offset:1024 lds
  v_exp_f32 v244, v244
  v_exp_f32 v246, v246
  v_exp_f32 v241, v241
  v_exp_f32 v243, v243
  v_exp_f32 v245, v245
  v_exp_f32 v247, v247
  v_pk_fma_f32 v[240:241], v[240:241], v[68:69], v[68:69] op_sel_hi:[1,0,0]
  v_pk_fma_f32 v[242:243], v[242:243], v[68:69], v[68:69] op_sel_hi:[1,0,0]
  v_pk_fma_f32 v[244:245], v[244:245], v[68:69], v[68:69] op_sel_hi:[1,0,0]
  v_pk_fma_f32 v[246:247], v[246:247], v[68:69], v[68:69] op_sel_hi:[1,0,0]
  v_rcp_f32 v240, v240
  v_rcp_f32 v242, v242
  buffer_load_dwordx4 v6, s[32:35], s59 offen offset:2048 lds
  v_rcp_f32 v244, v244
  v_rcp_f32 v246, v246
  v_rcp_f32 v241, v241
  v_rcp_f32 v243, v243
  v_rcp_f32 v245, v245
  v_rcp_f32 v247, v247
  v_pk_mul_f32 v[240:241], v[240:241], v[144:145]
  v_pk_mul_f32 v[242:243], v[242:243], v[146:147]
  v_pk_mul_f32 v[244:245], v[244:245], v[148:149]
  v_pk_mul_f32 v[246:247], v[246:247], v[150:151]
  v_cvt_pk_bf16_f32 v236, v240, v241
  buffer_load_dwordx4 v7, s[32:35], s59 offen offset:3072 lds
  v_cvt_pk_bf16_f32 v237, v242, v243
  v_cvt_pk_bf16_f32 v238, v244, v245
  v_cvt_pk_bf16_f32 v239, v246, v247
  buffer_store_dwordx4 v[236:239], v2, s[44:47], s70 offen offset:1024 sc1
  s_waitcnt lgkmcnt(3)
  v_pk_fma_f32 v[152:153], v[216:217], v[70:71], v[152:153] op_sel_hi:[1,0,1]
  v_pk_fma_f32 v[154:155], v[218:219], v[70:71], v[154:155] op_sel_hi:[1,0,1]
  s_waitcnt lgkmcnt(2)
  v_pk_fma_f32 v[156:157], v[220:221], v[70:71], v[156:157] op_sel_hi:[1,0,1]
  v_pk_fma_f32 v[158:159], v[222:223], v[70:71], v[158:159] op_sel_hi:[1,0,1]
  v_pk_mul_f32 v[240:241], v[152:153], v[152:153]
  v_pk_mul_f32 v[242:243], v[154:155], v[154:155]
  v_pk_mul_f32 v[244:245], v[156:157], v[156:157]
  v_pk_mul_f32 v[246:247], v[158:159], v[158:159]
  s_add_u32 s59, s56, 65536
  s_add_u32 m0, s51, 32768
  s_nop 0
  buffer_load_dwordx4 v4, s[32:35], s59 offen offset:0 lds
  v_pk_fma_f32 v[240:241], v[240:241], v[76:77], v[72:73] op_sel_hi:[1,0,0]
  v_pk_fma_f32 v[242:243], v[242:243], v[76:77], v[72:73] op_sel_hi:[1,0,0]
  v_pk_fma_f32 v[244:245], v[244:245], v[76:77], v[72:73] op_sel_hi:[1,0,0]
  v_pk_fma_f32 v[246:247], v[246:247], v[76:77], v[72:73] op_sel_hi:[1,0,0]
  v_pk_mul_f32 v[240:241], v[240:241], v[152:153]
  v_pk_mul_f32 v[242:243], v[242:243], v[154:155]
  v_pk_mul_f32 v[244:245], v[244:245], v[156:157]
  buffer_load_dword v35, v36, s[40:43], 0 offen sc1
  v_pk_mul_f32 v[246:247], v[246:247], v[158:159]
  v_exp_f32 v240, v240
  v_exp_f32 v242, v242
  v_exp_f32 v244, v244
  v_exp_f32 v246, v246
  buffer_load_dwordx4 v5, s[32:35], s59 offen offset:1024 lds
  v_exp_f32 v241, v241
  v_exp_f32 v243, v243
  v_exp_f32 v245, v245
  v_exp_f32 v247, v247
  v_pk_fma_f32 v[240:241], v[240:241], v[68:69], v[68:69] op_sel_hi:[1,0,0]
  v_pk_fma_f32 v[242:243], v[242:243], v[68:69], v[68:69] op_sel_hi:[1,0,0]
  v_pk_fma_f32 v[244:245], v[244:245], v[68:69], v[68:69] op_sel_hi:[1,0,0]
  v_pk_fma_f32 v[246:247], v[246:247], v[68:69], v[68:69] op_sel_hi:[1,0,0]
  v_rcp_f32 v240, v240
  v_rcp_f32 v242, v242
  v_rcp_f32 v244, v244
  v_rcp_f32 v246, v246
  buffer_load_dwordx4 v6, s[32:35], s59 offen offset:2048 lds
  v_rcp_f32 v241, v241
  v_rcp_f32 v243, v243
  v_rcp_f32 v245, v245
  v_rcp_f32 v247, v247
  v_pk_mul_f32 v[240:241], v[240:241], v[152:153]
  v_pk_mul_f32 v[242:243], v[242:243], v[154:155]
  v_pk_mul_f32 v[244:245], v[244:245], v[156:157]
  v_pk_mul_f32 v[246:247], v[246:247], v[158:159]
  v_cvt_pk_bf16_f32 v232, v240, v241
  v_cvt_pk_bf16_f32 v233, v242, v243
  v_cvt_pk_bf16_f32 v234, v244, v245
  buffer_load_dwordx4 v7, s[32:35], s59 offen offset:3072 lds
  v_cvt_pk_bf16_f32 v235, v246, v247
  buffer_store_dwordx4 v[232:235], v2, s[44:47], s70 offen offset:2048 sc1
  s_waitcnt lgkmcnt(1)
  v_pk_fma_f32 v[160:161], v[224:225], v[70:71], v[160:161] op_sel_hi:[1,0,1]
  v_pk_fma_f32 v[162:163], v[226:227], v[70:71], v[162:163] op_sel_hi:[1,0,1]
  s_waitcnt lgkmcnt(0)
  v_pk_fma_f32 v[164:165], v[228:229], v[70:71], v[164:165] op_sel_hi:[1,0,1]
  v_pk_fma_f32 v[166:167], v[230:231], v[70:71], v[166:167] op_sel_hi:[1,0,1]
  v_pk_mul_f32 v[240:241], v[160:161], v[160:161]
  v_pk_mul_f32 v[242:243], v[162:163], v[162:163]
  v_pk_mul_f32 v[244:245], v[164:165], v[164:165]
  v_pk_mul_f32 v[246:247], v[166:167], v[166:167]
  v_pk_fma_f32 v[240:241], v[240:241], v[76:77], v[72:73] op_sel_hi:[1,0,0]
  v_pk_fma_f32 v[242:243], v[242:243], v[76:77], v[72:73] op_sel_hi:[1,0,0]
  s_add_u32 s59, s56, 327680
  s_add_u32 m0, s51, 98304
  s_nop 0
  buffer_load_dwordx4 v4, s[32:35], s59 offen offset:0 lds
  v_pk_fma_f32 v[244:245], v[244:245], v[76:77], v[72:73] op_sel_hi:[1,0,0]
  v_pk_fma_f32 v[246:247], v[246:247], v[76:77], v[72:73] op_sel_hi:[1,0,0]
  v_pk_mul_f32 v[240:241], v[240:241], v[160:161]
  v_pk_mul_f32 v[242:243], v[242:243], v[162:163]
  v_pk_mul_f32 v[244:245], v[244:245], v[164:165]
  v_pk_mul_f32 v[246:247], v[246:247], v[166:167]
  v_exp_f32 v240, v240
  v_exp_f32 v242, v242
  v_exp_f32 v244, v244
  v_exp_f32 v246, v246
  v_exp_f32 v241, v241
  v_exp_f32 v243, v243
  buffer_load_dwordx4 v5, s[32:35], s59 offen offset:1024 lds
  v_exp_f32 v245, v245
  v_exp_f32 v247, v247
  v_pk_fma_f32 v[240:241], v[240:241], v[68:69], v[68:69] op_sel_hi:[1,0,0]
  v_pk_fma_f32 v[242:243], v[242:243], v[68:69], v[68:69] op_sel_hi:[1,0,0]
  v_pk_fma_f32 v[244:245], v[244:245], v[68:69], v[68:69] op_sel_hi:[1,0,0]
  v_pk_fma_f32 v[246:247], v[246:247], v[68:69], v[68:69] op_sel_hi:[1,0,0]
  v_rcp_f32 v240, v240
  v_rcp_f32 v242, v242
  v_rcp_f32 v244, v244
  v_rcp_f32 v246, v246
  v_rcp_f32 v241, v241
  v_rcp_f32 v243, v243
  buffer_load_dwordx4 v6, s[32:35], s59 offen offset:2048 lds
  v_rcp_f32 v245, v245
  v_rcp_f32 v247, v247
  v_pk_mul_f32 v[240:241], v[240:241], v[160:161]
  v_pk_mul_f32 v[242:243], v[242:243], v[162:163]
  v_pk_mul_f32 v[244:245], v[244:245], v[164:165]
  v_pk_mul_f32 v[246:247], v[246:247], v[166:167]
  v_cvt_pk_bf16_f32 v236, v240, v241
  v_cvt_pk_bf16_f32 v237, v242, v243
  v_cvt_pk_bf16_f32 v238, v244, v245
  v_cvt_pk_bf16_f32 v239, v246, v247
  buffer_store_dwordx4 v[236:239], v2, s[44:47], s70 offen offset:3072 sc1
  buffer_load_dwordx4 v7, s[32:35], s59 offen offset:3072 lds
  s_waitcnt vmcnt(9)
  v_cmp_ne_u32 vcc, v3, v35
  s_nop 0
  s_cbranch_vccz L_ok_13
  s_mov_b32 s63, 200000
L_spin_14:
  buffer_load_dword v35, v36, s[40:43], 0 offen sc1
  s_waitcnt vmcnt(0)
  v_cmp_ne_u32 vcc, v3, v35
  s_nop 0
  s_cbranch_vccz L_ok_13
  s_sub_u32 s63, s63, 1
  s_cbranch_scc0 L_spin_14
L_ok_13:
  s_lshl_b32 s60, s3, 8
  s_add_u32 s60, s60, 18198528
  v_lshl_add_u32 v36, v1, 2, s60
  buffer_load_dword v35, v36, s[40:43], 0 offen sc1
  ds_read_b64_tr_b16 v[224:225], v39 offset:0
  ds_read_b64_tr_b16 v[226:227], v39 offset:256
  ds_read_b64_tr_b16 v[228:229], v40 offset:1024
  ds_read_b64_tr_b16 v[230:231], v40 offset:1280
  s_lshl_b32 s60, s67, 7
  s_add_u32 s60, s60, 158720
  v_add_u32 v232, s60, v38
  ds_read_b128 v[104:107], v232 offset:0
  ds_read_b128 v[108:111], v232 offset:32
  ds_read_b128 v[112:115], v232 offset:64
  ds_read_b128 v[116:119], v232 offset:96
  s_waitcnt lgkmcnt(3)
  v_pk_fma_f32 v[168:169], v[104:105], v[42:43], v[168:169] op_sel_hi:[1,0,1]
  v_pk_fma_f32 v[170:171], v[106:107], v[42:43], v[170:171] op_sel_hi:[1,0,1]
  s_waitcnt lgkmcnt(2)
  v_pk_fma_f32 v[172:173], v[108:109], v[42:43], v[172:173] op_sel_hi:[1,0,1]
  v_pk_fma_f32 v[174:175], v[110:111], v[42:43], v[174:175] op_sel_hi:[1,0,1]
  s_waitcnt lgkmcnt(1)
  v_pk_fma_f32 v[176:177], v[112:113], v[42:43], v[176:177] op_sel_hi:[1,0,1]
  v_pk_fma_f32 v[178:179], v[114:115], v[42:43], v[178:179] op_sel_hi:[1,0,1]
  s_waitcnt lgkmcnt(0)
  v_pk_fma_f32 v[180:181], v[116:117], v[42:43], v[180:181] op_sel_hi:[1,0,1]
  s_add_u32 s71, s52, 0
  buffer_load_dwordx4 a[0:3], v2, s[40:43], s71 offen offset:0 sc1
  v_pk_fma_f32 v[182:183], v[118:119], v[42:43], v[182:183] op_sel_hi:[1,0,1]
  v_pk_mul_f32 v[168:169], v[168:169], v[44:45] op_sel_hi:[1,0]
  v_pk_mul_f32 v[170:171], v[170:171], v[44:45] op_sel_hi:[1,0]
  v_pk_mul_f32 v[172:173], v[172:173], v[44:45] op_sel_hi:[1,0]
  v_pk_mul_f32 v[174:175], v[174:175], v[44:45] op_sel_hi:[1,0]
  v_pk_mul_f32 v[176:177], v[176:177], v[44:45] op_sel_hi:[1,0]
  v_pk_mul_f32 v[178:179], v[178:179], v[44:45] op_sel_hi:[1,0]
  v_pk_mul_f32 v[180:181], v[180:181], v[44:45] op_sel_hi:[1,0]
  buffer_load_dwordx4 a[4:7], v2, s[40:43], s71 offen offset:1024 sc1
  v_pk_mul_f32 v[182:183], v[182:183], v[44:45] op_sel_hi:[1,0]
  v_cvt_pk_bf16_f32 v216, v168, v169
  v_cvt_pk_bf16_f32 v217, v170, v171
  v_cvt_pk_bf16_f32 v218, v172, v173
  v_cvt_pk_bf16_f32 v219, v174, v175
  v_cvt_pk_bf16_f32 v220, v176, v177
  v_cvt_pk_bf16_f32 v221, v178, v179
  v_cvt_pk_bf16_f32 v222, v180, v181
  buffer_load_dwordx4 a[8:11], v2, s[40:43], s71 offen offset:2048 sc1
  v_cvt_pk_bf16_f32 v223, v182, v183
  v_mfma_f32_32x32x16_bf16 v[200:215], v[224:227], v[216:219], 0
  s_nop 0
  v_mfma_f32_32x32x16_bf16 v[200:215], v[228:231], v[220:223], v[200:215]
  s_nop 11
  v_max3_f32 v216, v200, v201, v202
  v_max3_f32 v232, v208, v209, v210
  v_max3_f32 v217, -v200, -v201, -v202
  v_max3_f32 v233, -v208, -v209, -v210
  v_max3_f32 v216, v216, v203, v204
  buffer_load_dwordx4 a[12:15], v2, s[40:43], s71 offen offset:3072 sc1
  v_max3_f32 v232, v232, v211, v212
  v_max3_f32 v217, v217, -v203, -v204
  v_max3_f32 v233, v233, -v211, -v212
  v_max3_f32 v216, v216, v205, v206
  v_max3_f32 v232, v232, v213, v214
  v_max3_f32 v217, v217, -v205, -v206
  v_max3_f32 v233, v233, -v213, -v214
  v_max_f32 v216, v216, v207
  s_add_u32 s71, s52, 16384
  buffer_load_dwordx4 a[16:19], v2, s[40:43], s71 offen offset:0 sc1
  s_lshl_b32 s60, s64, 5
  s_add_u32 s60, s60, s65
  s_lshl_b32 s60, s60, 2
  s_add_u32 s60, s60, 18178048
  s_waitcnt vmcnt(7)
  buffer_store_dword v3, v34, s[44:47], s60 offen sc1
  v_max_f32 v232, v232, v215
  v_max_f32_e64 v217, v217, -v207
  v_max_f32_e64 v233, v233, -v215
  s_nop 0
  v_permlane32_swap_b32 v216, v217
  v_permlane32_swap_b32 v232, v233
  v_max_f32 v216, v216, v217
  v_max_f32 v232, v232, v233
  v_mul_f32 v218, 0xbfb8aa3b, v216
  buffer_load_dwordx4 a[20:23], v2, s[40:43], s71 offen offset:1024 sc1
  v_mul_f32 v234, 0xbfb8aa3b, v232
  v_mul_f32 v220, 0xbfb8aa3b, v216
  v_mul_f32 v236, 0xbfb8aa3b, v232
  s_nop 0
  v_permlane32_swap_b32 v218, v220
  v_permlane32_swap_b32 v234, v236
  v_pk_fma_f32 v[168:169], v[200:201], s[68:69], v[218:219] op_sel_hi:[1,1,0]
  v_pk_fma_f32 v[104:105], v[208:209], s[68:69], v[234:235] op_sel_hi:[1,1,0]
  v_pk_fma_f32 v[176:177], v[200:201], s[68:69], v[220:221] op_sel_hi:[1,1,0] neg_lo:[1,0,0] neg_hi:[1,0,0]
  buffer_load_dwordx4 a[24:27], v2, s[40:43], s71 offen offset:2048 sc1
  v_pk_fma_f32 v[112:113], v[208:209], s[68:69], v[236:237] op_sel_hi:[1,1,0] neg_lo:[1,0,0] neg_hi:[1,0,0]
  v_pk_fma_f32 v[170:171], v[202:203], s[68:69], v[218:219] op_sel_hi:[1,1,0]
  v_pk_fma_f32 v[106:107], v[210:211], s[68:69], v[234:235] op_sel_hi:[1,1,0]
  v_pk_fma_f32 v[178:179], v[202:203], s[68:69], v[220:221] op_sel_hi:[1,1,0] neg_lo:[1,0,0] neg_hi:[1,0,0]
  v_pk_fma_f32 v[114:115], v[210:211], s[68:69], v[236:237] op_sel_hi:[1,1,0] neg_lo:[1,0,0] neg_hi:[1,0,0]
  v_pk_fma_f32 v[172:173], v[204:205], s[68:69], v[218:219] op_sel_hi:[1,1,0]
  v_pk_fma_f32 v[108:109], v[212:213], s[68:69], v[234:235] op_sel_hi:[1,1,0]
  v_pk_fma_f32 v[180:181], v[204:205], s[68:69], v[220:221] op_sel_hi:[1,1,0] neg_lo:[1,0,0] neg_hi:[1,0,0]
  buffer_load_dwordx4 a[28:31], v2, s[40:43], s71 offen offset:3072 sc1
  v_pk_fma_f32 v[116:117], v[212:213], s[68:69], v[236:237] op_sel_hi:[1,1,0] neg_lo:[1,0,0] neg_hi:[1,0,0]
  v_pk_fma_f32 v[174:175], v[206:207], s[68:69], v[218:219] op_sel_hi:[1,1,0]
  v_pk_fma_f32 v[110:111], v[214:215], s[68:69], v[234:235] op_sel_hi:[1,1,0]
  v_pk_fma_f32 v[182:183], v[206:207], s[68:69], v[220:221] op_sel_hi:[1,1,0] neg_lo:[1,0,0] neg_hi:[1,0,0]
  v_pk_fma_f32 v[118:119], v[214:215], s[68:69], v[236:237] op_sel_hi:[1,1,0] neg_lo:[1,0,0] neg_hi:[1,0,0]
  v_exp_f32 v168, v168
  v_exp_f32 v104, v104
  v_exp_f32 v169, v169
  s_add_u32 s71, s52, 32768
  buffer_load_dwordx4 a[32:35], v2, s[40:43], s71 offen offset:0 sc1
  v_exp_f32 v105, v105
  v_exp_f32 v170, v170
  v_exp_f32 v106, v106
  v_exp_f32 v171, v171
  v_exp_f32 v107, v107
  v_exp_f32 v172, v172
  v_exp_f32 v108, v108
  v_exp_f32 v173, v173
  s_waitcnt vmcnt(10)
  v_cmp_ne_u32 vcc, v3, v35
  s_nop 0
  s_cbranch_vccz L_ok_15
  s_mov_b32 s63, 200000
L_spin_16:
  buffer_load_dword v35, v36, s[40:43], 0 offen sc1
  s_waitcnt vmcnt(0)
  v_cmp_ne_u32 vcc, v3, v35
  s_nop 0
  s_cbranch_vccz L_ok_15
  s_sub_u32 s63, s63, 1
  s_cbranch_scc0 L_spin_16
L_ok_15:
  s_lshl_b32 s61, s3, 12
  s_add_u32 s61, s61, 17825792
  buffer_load_dwordx4 v[120:123], v2, s[40:43], s61 offen offset:0 sc1
  buffer_load_dwordx4 v[124:127], v2, s[40:43], s61 offen offset:1024 sc1
  buffer_load_dwordx4 v[128:131], v2, s[40:43], s61 offen offset:2048 sc1
  buffer_load_dwordx4 v[132:135], v2, s[40:43], s61 offen offset:3072 sc1
  v_and_b32 v36, 15, v1
  v_min_u32 v36, 13, v36
  s_lshl_b32 s60, s73, 7
  s_add_u32 s60, s60, 18178048
  v_lshl_add_u32 v36, v36, 2, s60
  buffer_load_dwordx4 a[36:39], v2, s[40:43], s71 offen offset:1024 sc1
  v_exp_f32 v109, v109
  v_exp_f32 v174, v174
  v_exp_f32 v110, v110
  v_exp_f32 v175, v175
  v_exp_f32 v111, v111
  v_exp_f32 v176, v176
  v_exp_f32 v112, v112
  v_exp_f32 v177, v177
  buffer_load_dwordx4 a[40:43], v2, s[40:43], s71 offen offset:2048 sc1
  v_exp_f32 v113, v113
  v_exp_f32 v178, v178
  v_exp_f32 v114, v114
  v_exp_f32 v179, v179
  v_exp_f32 v115, v115
  v_exp_f32 v180, v180
  v_exp_f32 v116, v116
  v_exp_f32 v181, v181
  buffer_load_dwordx4 a[44:47], v2, s[40:43], s71 offen offset:3072 sc1
  v_exp_f32 v117, v117
  v_exp_f32 v182, v182
  v_exp_f32 v118, v118
  v_exp_f32 v183, v183
  v_exp_f32 v119, v119
  v_pk_add_f32 v[216:217], v[168:169], v[170:171]
  v_pk_add_f32 v[232:233], v[104:105], v[106:107]
  v_pk_add_f32 v[218:219], v[176:177], v[178:179]
  s_add_u32 s71, s52, 49152
  buffer_load_dwordx4 a[48:51], v2, s[40:43], s71 offen offset:0 sc1
  v_pk_add_f32 v[234:235], v[112:113], v[114:115]
  v_pk_add_f32 v[220:221], v[172:173], v[174:175]
  v_pk_add_f32 v[236:237], v[108:109], v[110:111]
  v_pk_add_f32 v[222:223], v[180:181], v[182:183]
  v_pk_add_f32 v[238:239], v[116:117], v[118:119]
  v_pk_add_f32 v[216:217], v[216:217], v[220:221]
  v_pk_add_f32 v[232:233], v[232:233], v[236:237]
  v_pk_add_f32 v[218:219], v[218:219], v[222:223]
  buffer_load_dwordx4 a[52:55], v2, s[40:43], s71 offen offset:1024 sc1
  v_pk_add_f32 v[234:235], v[234:235], v[238:239]
  v_add_f32 v216, v216, v217
  v_add_f32 v232, v232, v233
  v_add_f32 v218, v218, v219
  v_add_f32 v234, v234, v235
  s_nop 0
  v_permlane32_swap_b32 v216, v218
  v_permlane32_swap_b32 v232, v234
  v_add_f32 v216, v216, v218
  buffer_load_dwordx4 a[56:59], v2, s[40:43], s71 offen offset:2048 sc1
  v_add_f32 v232, v232, v234
  v_rcp_f32 v216, v216
  v_rcp_f32 v232, v232
  v_mov_b32 v218, v216
  v_mov_b32 v234, v232
  s_nop 0
  v_permlane32_swap_b32 v216, v218
  v_permlane32_swap_b32 v232, v234
  v_pk_mul_f32 v[168:169], v[168:169], v[216:217] op_sel_hi:[1,0]
  buffer_load_dwordx4 a[60:63], v2, s[40:43], s71 offen offset:3072 sc1
  v_pk_mul_f32 v[104:105], v[104:105], v[232:233] op_sel_hi:[1,0]
  v_pk_mul_f32 v[176:177], v[176:177], v[218:219] op_sel_hi:[1,0]
  v_pk_mul_f32 v[112:113], v[112:113], v[234:235] op_sel_hi:[1,0]
  v_pk_mul_f32 v[170:171], v[170:171], v[216:217] op_sel_hi:[1,0]
  v_pk_mul_f32 v[106:107], v[106:107], v[232:233] op_sel_hi:[1,0]
  v_pk_mul_f32 v[178:179], v[178:179], v[218:219] op_sel_hi:[1,0]
  v_pk_mul_f32 v[114:115], v[114:115], v[234:235] op_sel_hi:[1,0]
  v_pk_mul_f32 v[172:173], v[172:173], v[216:217] op_sel_hi:[1,0]
  s_add_u32 s71, s52, 65536
  buffer_load_dwordx4 a[64:67], v2, s[40:43], s71 offen offset:0 sc1
  v_pk_mul_f32 v[108:109], v[108:109], v[232:233] op_sel_hi:[1,0]
  v_pk_mul_f32 v[180:181], v[180:181], v[218:219] op_sel_hi:[1,0]
  v_pk_mul_f32 v[116:117], v[116:117], v[234:235] op_sel_hi:[1,0]
  v_pk_mul_f32 v[174:175], v[174:175], v[216:217] op_sel_hi:[1,0]
  v_pk_mul_f32 v[110:111], v[110:111], v[232:233] op_sel_hi:[1,0]
  v_pk_mul_f32 v[182:183], v[182:183], v[218:219] op_sel_hi:[1,0]
  v_pk_mul_f32 v[118:119], v[118:119], v[234:235] op_sel_hi:[1,0]
  v_cvt_pk_bf16_f32 v184, v168, v169
  buffer_load_dwordx4 a[68:71], v2, s[40:43], s71 offen offset:1024 sc1
  v_cvt_pk_bf16_f32 v192, v104, v105
  v_cvt_pk_bf16_f32 v185, v170, v171
  v_cvt_pk_bf16_f32 v193, v106, v107
  v_cvt_pk_bf16_f32 v186, v172, v173
  v_cvt_pk_bf16_f32 v194, v108, v109
  v_cvt_pk_bf16_f32 v187, v174, v175
  v_cvt_pk_bf16_f32 v195, v110, v111
  v_cvt_pk_bf16_f32 v188, v176, v177
  buffer_load_dwordx4 a[72:75], v2, s[40:43], s71 offen offset:2048 sc1
  v_cvt_pk_bf16_f32 v196, v112, v113
  v_cvt_pk_bf16_f32 v189, v178, v179
  v_cvt_pk_bf16_f32 v197, v114, v115
  v_cvt_pk_bf16_f32 v190, v180, v181
  v_cvt_pk_bf16_f32 v198, v116, v117
  v_cvt_pk_bf16_f32 v191, v182, v183
  v_cvt_pk_bf16_f32 v199, v118, v119
  buffer_load_dwordx4 a[76:79], v2, s[40:43], s71 offen offset:3072 sc1
  s_lshl4_add_u32 s61, s73, s3
  s_lshl_b32 s61, s61, 11
  s_add_u32 s61, s61, 4194304
  s_waitcnt vmcnt(14)
  v_mfma_f32_32x32x16_bf16 v[136:151], v[120:123], v[184:187], 0
  s_waitcnt vmcnt(12)
  v_mfma_f32_32x32x16_bf16 v[152:167], v[128:131], v[192:195], 0
  v_mfma_f32_32x32x16_bf16 v[136:151], v[124:127], v[188:191], v[136:151]
  s_waitcnt vmcnt(11)
  v_mfma_f32_32x32x16_bf16 v[152:167], v[132:135], v[196:199], v[152:167]
  s_add_u32 s71, s52, 81920
  buffer_load_dwordx4 a[80:83], v2, s[40:43], s71 offen offset:0 sc1
  buffer_load_dwordx4 a[84:87], v2, s[40:43], s71 offen offset:1024 sc1
  s_nop 6
  v_add_f32 v144, 0x358637bd, v144
  v_rcp_f32 v144, v144
  v_add_f32 v152, 0x358637bd, v152
  v_rcp_f32 v152, v152
  v_pk_mul_f32 v[136:137], v[136:137], v[144:145] op_sel_hi:[1,0]
  v_pk_mul_f32 v[138:139], v[138:139], v[144:145] op_sel_hi:[1,0]
  v_pk_mul_f32 v[140:141], v[140:141], v[144:145] op_sel_hi:[1,0]
  v_pk_mul_f32 v[142:143], v[142:143], v[144:145] op_sel_hi:[1,0]
  v_cvt_pk_bf16_f32 v200, v136, v137
  v_cvt_pk_bf16_f32 v201, v138, v139
  v_cvt_pk_bf16_f32 v202, v140, v141
  v_cvt_pk_bf16_f32 v203, v142, v143
  buffer_store_dwordx4 v[200:203], v2, s[40:43], s61 offen offset:0 sc1
  v_pk_mul_f32 v[160:161], v[160:161], v[152:153] op_sel_hi:[1,0]
  v_pk_mul_f32 v[162:163], v[162:163], v[152:153] op_sel_hi:[1,0]
  v_pk_mul_f32 v[164:165], v[164:165], v[152:153] op_sel_hi:[1,0]
  v_pk_mul_f32 v[166:167], v[166:167], v[152:153] op_sel_hi:[1,0]
  v_cvt_pk_bf16_f32 v204, v160, v161
  v_cvt_pk_bf16_f32 v205, v162, v163
  v_cvt_pk_bf16_f32 v206, v164, v165
  v_cvt_pk_bf16_f32 v207, v166, v167
  buffer_store_dwordx4 v[204:207], v2, s[40:43], s61 offen offset:1024 sc1
  s_barrier
  ds_read_b64_tr_b16 v[80:81], v28 offset:49152
  ds_read_b64_tr_b16 v[82:83], v28 offset:50176
  ds_read_b64_tr_b16 v[84:85], v31 offset:49152
  ds_read_b64_tr_b16 v[86:87], v31 offset:50176
  ds_read_b64_tr_b16 v[88:89], v28 offset:51200
  ds_read_b64_tr_b16 v[90:91], v28 offset:52224
  ds_read_b64_tr_b16 v[92:93], v31 offset:51200
  ds_read_b64_tr_b16 v[94:95], v31 offset:52224
  ds_read_b64_tr_b16 v[96:97], v28 offset:53248
  ds_read_b64_tr_b16 v[98:99], v28 offset:54272
  s_waitcnt lgkmcnt(8)
  v_mfma_f32_32x32x16_bf16 v[104:119], v[80:83], a[0:3], 0
  ds_read_b64_tr_b16 v[100:101], v31 offset:53248
  ds_read_b64_tr_b16 v[102:103], v31 offset:54272
  s_waitcnt lgkmcnt(8)
  v_mfma_f32_32x32x16_bf16 v[120:135], v[84:87], a[0:3], 0
  buffer_load_dwordx4 a[88:91], v2, s[40:43], s71 offen offset:2048 sc1
  ds_read_b64_tr_b16 v[80:81], v28 offset:55296
  ds_read_b64_tr_b16 v[82:83], v28 offset:56320
  s_waitcnt lgkmcnt(8)
  v_mfma_f32_32x32x16_bf16 v[104:119], v[88:91], a[4:7], v[104:119]
  buffer_load_dwordx4 a[92:95], v2, s[40:43], s71 offen offset:3072 sc1
  ds_read_b64_tr_b16 v[84:85], v31 offset:55296
  ds_read_b64_tr_b16 v[86:87], v31 offset:56320
  s_waitcnt lgkmcnt(8)
  v_mfma_f32_32x32x16_bf16 v[120:135], v[92:95], a[4:7], v[120:135]
  s_barrier
  ds_read_b64_tr_b16 v[88:89], v29 offset:49152
  ds_read_b64_tr_b16 v[90:91], v29 offset:50176
  s_waitcnt lgkmcnt(8)
  v_mfma_f32_32x32x16_bf16 v[104:119], v[96:99], a[8:11], v[104:119]
  s_add_u32 s71, s52, 98304
  buffer_load_dwordx4 a[96:99], v2, s[40:43], s71 offen offset:0 sc1
  ds_read_b64_tr_b16 v[92:93], v32 offset:49152
  ds_read_b64_tr_b16 v[94:95], v32 offset:50176
  s_waitcnt lgkmcnt(8)
  v_mfma_f32_32x32x16_bf16 v[120:135], v[100:103], a[8:11], v[120:135]
  buffer_load_dwordx4 a[100:103], v2, s[40:43], s71 offen offset:1024 sc1
  ds_read_b64_tr_b16 v[96:97], v29 offset:51200
  ds_read_b64_tr_b16 v[98:99], v29 offset:52224
  s_waitcnt lgkmcnt(8)
  v_mfma_f32_32x32x16_bf16 v[104:119], v[80:83], a[12:15], v[104:119]
  ds_read_b64_tr_b16 v[100:101], v32 offset:51200
  ds_read_b64_tr_b16 v[102:103], v32 offset:52224
  s_waitcnt lgkmcnt(8)
  v_mfma_f32_32x32x16_bf16 v[120:135], v[84:87], a[12:15], v[120:135]
  buffer_load_dwordx4 a[104:107], v2, s[40:43], s71 offen offset:2048 sc1
  ds_read_b64_tr_b16 v[80:81], v29 offset:53248
  ds_read_b64_tr_b16 v[82:83], v29 offset:54272
  s_waitcnt lgkmcnt(8)
  v_mfma_f32_32x32x16_bf16 v[104:119], v[88:91], a[16:19], v[104:119]
  buffer_load_dwordx4 a[108:111], v2, s[40:43], s71 offen offset:3072 sc1
  ds_read_b64_tr_b16 v[84:85], v32 offset:53248
  ds_read_b64_tr_b16 v[86:87], v32 offset:54272
  s_waitcnt lgkmcnt(8)
  v_mfma_f32_32x32x16_bf16 v[120:135], v[92:95], a[16:19], v[120:135]
  ds_read_b64_tr_b16 v[88:89], v29 offset:55296
  ds_read_b64_tr_b16 v[90:91], v29 offset:56320
  s_waitcnt lgkmcnt(8)
  v_mfma_f32_32x32x16_bf16 v[104:119], v[96:99], a[20:23], v[104:119]
  ds_read_b64_tr_b16 v[92:93], v32 offset:55296
  ds_read_b64_tr_b16 v[94:95], v32 offset:56320
  s_waitcnt lgkmcnt(8)
  v_mfma_f32_32x32x16_bf16 v[120:135], v[100:103], a[20:23], v[120:135]
  s_add_u32 s60, s2, 18186240
  s_waitcnt vmcnt(6)
  buffer_store_dword v3, v34, s[40:43], s60 offen sc1
  s_barrier
  ds_read_b64_tr_b16 v[96:97], v28 offset:0
  ds_read_b64_tr_b16 v[98:99], v28 offset:1024
  s_waitcnt lgkmcnt(8)
  v_mfma_f32_32x32x16_bf16 v[104:119], v[80:83], a[24:27], v[104:119]
  buffer_load_dword v35, v36, s[40:43], 0 offen sc1
  s_add_u32 s59, s56, 589824
  s_add_u32 m0, s51, 49152
  s_nop 0
  buffer_load_dwordx4 v4, s[32:35], s59 offen offset:0 lds
  buffer_load_dwordx4 v5, s[32:35], s59 offen offset:1024 lds
  ds_read_b64_tr_b16 v[100:101], v31 offset:0
  ds_read_b64_tr_b16 v[102:103], v31 offset:1024
  s_waitcnt lgkmcnt(8)
  v_mfma_f32_32x32x16_bf16 v[120:135], v[84:87], a[24:27], v[120:135]
  buffer_load_dwordx4 v6, s[32:35], s59 offen offset:2048 lds
  ds_read_b64_tr_b16 v[80:81], v28 offset:2048
  ds_read_b64_tr_b16 v[82:83], v28 offset:3072
  s_waitcnt lgkmcnt(8)
  v_mfma_f32_32x32x16_bf16 v[104:119], v[88:91], a[28:31], v[104:119]
  buffer_load_dwordx4 v7, s[32:35], s59 offen offset:3072 lds
  ds_read_b64_tr_b16 v[84:85], v31 offset:2048
  ds_read_b64_tr_b16 v[86:87], v31 offset:3072
  s_waitcnt lgkmcnt(8)
  v_mfma_f32_32x32x16_bf16 v[120:135], v[92:95], a[28:31], v[120:135]
  ds_read_b64_tr_b16 v[88:89], v28 offset:4096
  ds_read_b64_tr_b16 v[90:91], v28 offset:5120
  s_waitcnt lgkmcnt(8)
  v_mfma_f32_32x32x16_bf16 v[104:119], v[96:99], a[32:35], v[104:119]
  ds_read_b64_tr_b16 v[92:93], v31 offset:4096
  ds_read_b64_tr_b16 v[94:95], v31 offset:5120
  s_waitcnt lgkmcnt(8)
  v_mfma_f32_32x32x16_bf16 v[120:135], v[100:103], a[32:35], v[120:135]
  ds_read_b64_tr_b16 v[96:97], v28 offset:6144
  ds_read_b64_tr_b16 v[98:99], v28 offset:7168
  s_waitcnt lgkmcnt(8)
  v_mfma_f32_32x32x16_bf16 v[104:119], v[80:83], a[36:39], v[104:119]
  ds_read_b64_tr_b16 v[100:101], v31 offset:6144
  ds_read_b64_tr_b16 v[102:103], v31 offset:7168
  s_waitcnt lgkmcnt(8)
  v_mfma_f32_32x32x16_bf16 v[120:135], v[84:87], a[36:39], v[120:135]
  s_barrier
  ds_read_b64_tr_b16 v[80:81], v29 offset:0
  ds_read_b64_tr_b16 v[82:83], v29 offset:1024
  s_waitcnt lgkmcnt(8)
  v_mfma_f32_32x32x16_bf16 v[104:119], v[88:91], a[40:43], v[104:119]
  s_add_u32 s59, s56, 851968
  s_add_u32 m0, s51, 114688
  s_nop 0
  buffer_load_dwordx4 v4, s[32:35], s59 offen offset:0 lds
  buffer_load_dwordx4 v5, s[32:35], s59 offen offset:1024 lds
  ds_read_b64_tr_b16 v[84:85], v32 offset:0
  ds_read_b64_tr_b16 v[86:87], v32 offset:1024
  s_waitcnt lgkmcnt(8)
  v_mfma_f32_32x32x16_bf16 v[120:135], v[92:95], a[40:43], v[120:135]
  buffer_load_dwordx4 v6, s[32:35], s59 offen offset:2048 lds
  ds_read_b64_tr_b16 v[88:89], v29 offset:2048
  ds_read_b64_tr_b16 v[90:91], v29 offset:3072
  s_waitcnt lgkmcnt(8)
  v_mfma_f32_32x32x16_bf16 v[104:119], v[96:99], a[44:47], v[104:119]
  buffer_load_dwordx4 v7, s[32:35], s59 offen offset:3072 lds
  ds_read_b64_tr_b16 v[92:93], v32 offset:2048
  ds_read_b64_tr_b16 v[94:95], v32 offset:3072
  s_waitcnt lgkmcnt(8)
  v_mfma_f32_32x32x16_bf16 v[120:135], v[100:103], a[44:47], v[120:135]
  ds_read_b64_tr_b16 v[96:97], v29 offset:4096
  ds_read_b64_tr_b16 v[98:99], v29 offset:5120
  s_waitcnt lgkmcnt(8)
  v_mfma_f32_32x32x16_bf16 v[104:119], v[80:83], a[48:51], v[104:119]
  ds_read_b64_tr_b16 v[100:101], v32 offset:4096
  ds_read_b64_tr_b16 v[102:103], v32 offset:5120
  s_waitcnt lgkmcnt(8)
  v_mfma_f32_32x32x16_bf16 v[120:135], v[84:87], a[48:51], v[120:135]
  s_waitcnt vmcnt(8)
  v_cmp_ne_u32 vcc, v3, v35
  s_nop 0
  s_cbranch_vccz L_ok_17
  s_mov_b32 s63, 200000
L_spin_18:
  buffer_load_dword v35, v36, s[40:43], 0 offen sc1
  s_waitcnt vmcnt(0)
  v_cmp_ne_u32 vcc, v3, v35
  s_nop 0
  s_cbranch_vccz L_ok_17
  s_sub_u32 s63, s63, 1
  s_cbranch_scc0 L_spin_18
L_ok_17:
  v_and_b32 v36, 15, v1
  s_lshl_b32 s60, s73, 7
  s_add_u32 s60, s60, 18186240
  v_lshl_add_u32 v36, v36, 2, s60
  s_add_u32 s71, s52, 4096
  buffer_load_dwordx4 a[112:115], v2, s[40:43], s71 offen offset:0 sc1
  buffer_load_dwordx4 a[116:119], v2, s[40:43], s71 offen offset:1024 sc1
  ds_read_b64_tr_b16 v[80:81], v29 offset:6144
  ds_read_b64_tr_b16 v[82:83], v29 offset:7168
  s_waitcnt lgkmcnt(8)
  v_mfma_f32_32x32x16_bf16 v[104:119], v[88:91], a[52:55], v[104:119]
  ds_read_b64_tr_b16 v[84:85], v32 offset:6144
  ds_read_b64_tr_b16 v[86:87], v32 offset:7168
  s_waitcnt lgkmcnt(8)
  v_mfma_f32_32x32x16_bf16 v[120:135], v[92:95], a[52:55], v[120:135]
  buffer_load_dwordx4 a[120:123], v2, s[40:43], s71 offen offset:2048 sc1
  s_barrier
  ds_read_b64_tr_b16 v[88:89], v28 offset:16384
  ds_read_b64_tr_b16 v[90:91], v28 offset:17408
  s_waitcnt lgkmcnt(8)
  v_mfma_f32_32x32x16_bf16 v[104:119], v[96:99], a[56:59], v[104:119]
  buffer_load_dwordx4 a[124:127], v2, s[40:43], s71 offen offset:3072 sc1
  ds_read_b64_tr_b16 v[92:93], v31 offset:16384
  ds_read_b64_tr_b16 v[94:95], v31 offset:17408
  s_waitcnt lgkmcnt(8)
  v_mfma_f32_32x32x16_bf16 v[120:135], v[100:103], a[56:59], v[120:135]
  ds_read_b64_tr_b16 v[96:97], v28 offset:18432
  ds_read_b64_tr_b16 v[98:99], v28 offset:19456
  s_waitcnt lgkmcnt(8)
  v_mfma_f32_32x32x16_bf16 v[104:119], v[80:83], a[60:63], v[104:119]
  s_add_u32 s71, s52, 20480
  buffer_load_dwordx4 a[128:131], v2, s[40:43], s71 offen offset:0 sc1
  ds_read_b64_tr_b16 v[100:101], v31 offset:18432
  ds_read_b64_tr_b16 v[102:103], v31 offset:19456
  s_waitcnt lgkmcnt(8)
  v_mfma_f32_32x32x16_bf16 v[120:135], v[84:87], a[60:63], v[120:135]
  buffer_load_dwordx4 a[132:135], v2, s[40:43], s71 offen offset:1024 sc1
  ds_read_b64_tr_b16 v[80:81], v28 offset:20480
  ds_read_b64_tr_b16 v[82:83], v28 offset:21504
  s_waitcnt lgkmcnt(8)
  v_mfma_f32_32x32x16_bf16 v[104:119], v[88:91], a[64:67], v[104:119]
  ds_read_b64_tr_b16 v[84:85], v31 offset:20480
  ds_read_b64_tr_b16 v[86:87], v31 offset:21504
  s_waitcnt lgkmcnt(8)
  v_mfma_f32_32x32x16_bf16 v[120:135], v[92:95], a[64:67], v[120:135]
  buffer_load_dwordx4 a[136:139], v2, s[40:43], s71 offen offset:2048 sc1
  ds_read_b64_tr_b16 v[88:89], v28 offset:22528
  ds_read_b64_tr_b16 v[90:91], v28 offset:23552
  s_waitcnt lgkmcnt(8)
  v_mfma_f32_32x32x16_bf16 v[104:119], v[96:99], a[68:71], v[104:119]
  buffer_load_dwordx4 a[140:143], v2, s[40:43], s71 offen offset:3072 sc1
  ds_read_b64_tr_b16 v[92:93], v31 offset:22528
  ds_read_b64_tr_b16 v[94:95], v31 offset:23552
  s_waitcnt lgkmcnt(8)
  v_mfma_f32_32x32x16_bf16 v[120:135], v[100:103], a[68:71], v[120:135]
  s_add_u32 s71, s52, 36864
  buffer_load_dwordx4 a[144:147], v2, s[40:43], s71 offen offset:0 sc1
  s_barrier
  ds_read_b64_tr_b16 v[96:97], v30 offset:0
  ds_read_b64_tr_b16 v[98:99], v30 offset:1024
  s_waitcnt lgkmcnt(8)
  v_mfma_f32_32x32x16_bf16 v[104:119], v[80:83], a[72:75], v[104:119]
  ds_read_b64_tr_b16 v[100:101], v33 offset:0
  ds_read_b64_tr_b16 v[102:103], v33 offset:1024
  s_waitcnt lgkmcnt(8)
  v_mfma_f32_32x32x16_bf16 v[120:135], v[84:87], a[72:75], v[120:135]
  buffer_load_dwordx4 a[148:151], v2, s[40:43], s71 offen offset:1024 sc1
  ds_read_b64_tr_b16 v[80:81], v30 offset:2048
  ds_read_b64_tr_b16 v[82:83], v30 offset:3072
  s_waitcnt lgkmcnt(8)
  v_mfma_f32_32x32x16_bf16 v[104:119], v[88:91], a[76:79], v[104:119]
  buffer_load_dwordx4 a[152:155], v2, s[40:43], s71 offen offset:2048 sc1
  ds_read_b64_tr_b16 v[84:85], v33 offset:2048
  ds_read_b64_tr_b16 v[86:87], v33 offset:3072
  s_waitcnt lgkmcnt(8)
  v_mfma_f32_32x32x16_bf16 v[120:135], v[92:95], a[76:79], v[120:135]
  ds_read_b64_tr_b16 v[88:89], v30 offset:4096
  ds_read_b64_tr_b16 v[90:91], v30 offset:5120
  s_waitcnt lgkmcnt(8)
  v_mfma_f32_32x32x16_bf16 v[104:119], v[96:99], a[80:83], v[104:119]
  buffer_load_dwordx4 a[156:159], v2, s[40:43], s71 offen offset:3072 sc1
  ds_read_b64_tr_b16 v[92:93], v33 offset:4096
  ds_read_b64_tr_b16 v[94:95], v33 offset:5120
  s_waitcnt lgkmcnt(8)
  v_mfma_f32_32x32x16_bf16 v[120:135], v[100:103], a[80:83], v[120:135]
  s_add_u32 s71, s52, 53248
  buffer_load_dwordx4 a[160:163], v2, s[40:43], s71 offen offset:0 sc1
  ds_read_b64_tr_b16 v[96:97], v30 offset:6144
  ds_read_b64_tr_b16 v[98:99], v30 offset:7168
  s_waitcnt lgkmcnt(8)
  v_mfma_f32_32x32x16_bf16 v[104:119], v[80:83], a[84:87], v[104:119]
  ds_read_b64_tr_b16 v[100:101], v33 offset:6144
  ds_read_b64_tr_b16 v[102:103], v33 offset:7168
  s_waitcnt lgkmcnt(8)
  v_mfma_f32_32x32x16_bf16 v[120:135], v[84:87], a[84:87], v[120:135]
  s_add_u32 s59, s56, 1114112
  s_add_u32 m0, s51, 0
  s_nop 0
  buffer_load_dwordx4 v4, s[32:35], s59 offen offset:0 lds
  s_barrier
  ds_read_b64_tr_b16 v[80:81], v29 offset:16384
  ds_read_b64_tr_b16 v[82:83], v29 offset:17408
  s_waitcnt lgkmcnt(8)
  v_mfma_f32_32x32x16_bf16 v[104:119], v[88:91], a[88:91], v[104:119]
  buffer_load_dwordx4 a[164:167], v2, s[40:43], s71 offen offset:1024 sc1
  ds_read_b64_tr_b16 v[84:85], v32 offset:16384
  ds_read_b64_tr_b16 v[86:87], v32 offset:17408
  s_waitcnt lgkmcnt(8)
  v_mfma_f32_32x32x16_bf16 v[120:135], v[92:95], a[88:91], v[120:135]
  ds_read_b64_tr_b16 v[88:89], v29 offset:18432
  ds_read_b64_tr_b16 v[90:91], v29 offset:19456
  s_waitcnt lgkmcnt(8)
  v_mfma_f32_32x32x16_bf16 v[104:119], v[96:99], a[92:95], v[104:119]
  buffer_load_dwordx4 v5, s[32:35], s59 offen offset:1024 lds
  ds_read_b64_tr_b16 v[92:93], v32 offset:18432
  ds_read_b64_tr_b16 v[94:95], v32 offset:19456
  s_waitcnt lgkmcnt(8)
  v_mfma_f32_32x32x16_bf16 v[120:135], v[100:103], a[92:95], v[120:135]
  buffer_load_dwordx4 a[168:171], v2, s[40:43], s71 offen offset:2048 sc1
  ds_read_b64_tr_b16 v[96:97], v29 offset:20480
  ds_read_b64_tr_b16 v[98:99], v29 offset:21504
  s_waitcnt lgkmcnt(8)
  v_mfma_f32_32x32x16_bf16 v[104:119], v[80:83], a[96:99], v[104:119]
  buffer_load_dwordx4 v6, s[32:35], s59 offen offset:2048 lds
  ds_read_b64_tr_b16 v[100:101], v32 offset:20480
  ds_read_b64_tr_b16 v[102:103], v32 offset:21504
  s_waitcnt lgkmcnt(8)
  v_mfma_f32_32x32x16_bf16 v[120:135], v[84:87], a[96:99], v[120:135]
  ds_read_b64_tr_b16 v[80:81], v29 offset:22528
  ds_read_b64_tr_b16 v[82:83], v29 offset:23552
  s_waitcnt lgkmcnt(8)
  v_mfma_f32_32x32x16_bf16 v[104:119], v[88:91], a[100:103], v[104:119]
  buffer_load_dwordx4 a[172:175], v2, s[40:43], s71 offen offset:3072 sc1
  ds_read_b64_tr_b16 v[84:85], v32 offset:22528
  ds_read_b64_tr_b16 v[86:87], v32 offset:23552
  s_waitcnt lgkmcnt(8)
  v_mfma_f32_32x32x16_bf16 v[120:135], v[92:95], a[100:103], v[120:135]
  buffer_load_dwordx4 v7, s[32:35], s59 offen offset:3072 lds
  s_barrier
  ds_read_b64_tr_b16 v[88:89], v28 offset:32768
  ds_read_b64_tr_b16 v[90:91], v28 offset:33792
  s_waitcnt lgkmcnt(8)
  v_mfma_f32_32x32x16_bf16 v[104:119], v[96:99], a[104:107], v[104:119]
  ds_read_b64_tr_b16 v[92:93], v31 offset:32768
  ds_read_b64_tr_b16 v[94:95], v31 offset:33792
  s_waitcnt lgkmcnt(8)
  v_mfma_f32_32x32x16_bf16 v[120:135], v[100:103], a[104:107], v[120:135]
  s_add_u32 s71, s52, 69632
  buffer_load_dwordx4 a[176:179], v2, s[40:43], s71 offen offset:0 sc1
  ds_read_b64_tr_b16 v[96:97], v28 offset:34816
  ds_read_b64_tr_b16 v[98:99], v28 offset:35840
  s_waitcnt lgkmcnt(8)
  v_mfma_f32_32x32x16_bf16 v[104:119], v[80:83], a[108:111], v[104:119]
  s_add_u32 s59, s56, 1376256
  s_add_u32 m0, s51, 65536
  s_nop 0
  buffer_load_dwordx4 v4, s[32:35], s59 offen offset:0 lds
  ds_read_b64_tr_b16 v[100:101], v31 offset:34816
  ds_read_b64_tr_b16 v[102:103], v31 offset:35840
  s_waitcnt lgkmcnt(8)
  v_mfma_f32_32x32x16_bf16 v[120:135], v[84:87], a[108:111], v[120:135]
  ds_read_b64_tr_b16 v[80:81], v28 offset:36864
  ds_read_b64_tr_b16 v[82:83], v28 offset:37888
  s_waitcnt vmcnt(21) lgkmcnt(8)
  v_mfma_f32_32x32x16_bf16 v[104:119], v[88:91], a[112:115], v[104:119]
  buffer_load_dwordx4 a[180:183], v2, s[40:43], s71 offen offset:1024 sc1
  ds_read_b64_tr_b16 v[84:85], v31 offset:36864
  ds_read_b64_tr_b16 v[86:87], v31 offset:37888
  s_waitcnt lgkmcnt(8)
  v_mfma_f32_32x32x16_bf16 v[120:135], v[92:95], a[112:115], v[120:135]
  buffer_load_dwordx4 v5, s[32:35], s59 offen offset:1024 lds
  ds_read_b64_tr_b16 v[88:89], v28 offset:38912
  ds_read_b64_tr_b16 v[90:91], v28 offset:39936
  s_waitcnt vmcnt(22) lgkmcnt(8)
  v_mfma_f32_32x32x16_bf16 v[104:119], v[96:99], a[116:119], v[104:119]
  ds_read_b64_tr_b16 v[92:93], v31 offset:38912
  ds_read_b64_tr_b16 v[94:95], v31 offset:39936
  s_waitcnt lgkmcnt(8)
  v_mfma_f32_32x32x16_bf16 v[120:135], v[100:103], a[116:119], v[120:135]
  buffer_load_dwordx4 a[184:187], v2, s[40:43], s71 offen offset:2048 sc1
  s_barrier
  ds_read_b64_tr_b16 v[96:97], v29 offset:32768
  ds_read_b64_tr_b16 v[98:99], v29 offset:33792
  s_waitcnt vmcnt(22) lgkmcnt(8)
  v_mfma_f32_32x32x16_bf16 v[104:119], v[80:83], a[120:123], v[104:119]
  buffer_load_dword v35, v36, s[40:43], 0 offen sc1
  buffer_load_dwordx4 v6, s[32:35], s59 offen offset:2048 lds
  ds_read_b64_tr_b16 v[100:101], v32 offset:32768
  ds_read_b64_tr_b16 v[102:103], v32 offset:33792
  s_waitcnt lgkmcnt(8)
  v_mfma_f32_32x32x16_bf16 v[120:135], v[84:87], a[120:123], v[120:135]
  ds_read_b64_tr_b16 v[80:81], v29 offset:34816
  ds_read_b64_tr_b16 v[82:83], v29 offset:35840
  s_waitcnt vmcnt(23) lgkmcnt(8)
  v_mfma_f32_32x32x16_bf16 v[104:119], v[88:91], a[124:127], v[104:119]
  buffer_load_dwordx4 a[188:191], v2, s[40:43], s71 offen offset:3072 sc1
  ds_read_b64_tr_b16 v[84:85], v32 offset:34816
  ds_read_b64_tr_b16 v[86:87], v32 offset:35840
  s_waitcnt lgkmcnt(8)
  v_mfma_f32_32x32x16_bf16 v[120:135], v[92:95], a[124:127], v[120:135]
  buffer_load_dwordx4 v7, s[32:35], s59 offen offset:3072 lds
  ds_read_b64_tr_b16 v[88:89], v29 offset:36864
  ds_read_b64_tr_b16 v[90:91], v29 offset:37888
  s_waitcnt vmcnt(24) lgkmcnt(8)
  v_mfma_f32_32x32x16_bf16 v[104:119], v[96:99], a[128:131], v[104:119]
  s_add_u32 s71, s52, 86016
  buffer_load_dwordx4 a[192:195], v2, s[40:43], s71 offen offset:0 sc1
  ds_read_b64_tr_b16 v[92:93], v32 offset:36864
  ds_read_b64_tr_b16 v[94:95], v32 offset:37888
  s_waitcnt lgkmcnt(8)
  v_mfma_f32_32x32x16_bf16 v[120:135], v[100:103], a[128:131], v[120:135]
  ds_read_b64_tr_b16 v[96:97], v29 offset:38912
  ds_read_b64_tr_b16 v[98:99], v29 offset:39936
  s_waitcnt vmcnt(24) lgkmcnt(8)
  v_mfma_f32_32x32x16_bf16 v[104:119], v[80:83], a[132:135], v[104:119]
  s_add_u32 s59, s56, 1638400
  s_add_u32 m0, s51, 16384
  s_nop 0
  buffer_load_dwordx4 v4, s[32:35], s59 offen offset:0 lds
  ds_read_b64_tr_b16 v[100:101], v32 offset:38912
  ds_read_b64_tr_b16 v[102:103], v32 offset:39936
  s_waitcnt lgkmcnt(8)
  v_mfma_f32_32x32x16_bf16 v[120:135], v[84:87], a[132:135], v[120:135]
  buffer_load_dwordx4 a[196:199], v2, s[40:43], s71 offen offset:1024 sc1
  s_barrier
  ds_read_b64_tr_b16 v[80:81], v28 offset:49152
  ds_read_b64_tr_b16 v[82:83], v28 offset:50176
  s_waitcnt vmcnt(25) lgkmcnt(8)
  v_mfma_f32_32x32x16_bf16 v[104:119], v[88:91], a[136:139], v[104:119]
  ds_read_b64_tr_b16 v[84:85], v31 offset:49152
  ds_read_b64_tr_b16 v[86:87], v31 offset:50176
  s_waitcnt lgkmcnt(8)
  v_mfma_f32_32x32x16_bf16 v[120:135], v[92:95], a[136:139], v[120:135]
  buffer_load_dwordx4 v5, s[32:35], s59 offen offset:1024 lds
  ds_read_b64_tr_b16 v[88:89], v28 offset:51200
  ds_read_b64_tr_b16 v[90:91], v28 offset:52224
  s_waitcnt vmcnt(25) lgkmcnt(8)
  v_mfma_f32_32x32x16_bf16 v[104:119], v[96:99], a[140:143], v[104:119]
  buffer_load_dwordx4 a[200:203], v2, s[40:43], s71 offen offset:2048 sc1
  ds_read_b64_tr_b16 v[92:93], v31 offset:51200
  ds_read_b64_tr_b16 v[94:95], v31 offset:52224
  s_waitcnt lgkmcnt(8)
  v_mfma_f32_32x32x16_bf16 v[120:135], v[100:103], a[140:143], v[120:135]
  ds_read_b64_tr_b16 v[96:97], v28 offset:53248
  ds_read_b64_tr_b16 v[98:99], v28 offset:54272
  s_waitcnt vmcnt(25) lgkmcnt(8)
  v_mfma_f32_32x32x16_bf16 v[104:119], v[80:83], a[144:147], v[104:119]
  buffer_load_dwordx4 v6, s[32:35], s59 offen offset:2048 lds
  ds_read_b64_tr_b16 v[100:101], v31 offset:53248
  ds_read_b64_tr_b16 v[102:103], v31 offset:54272
  s_waitcnt lgkmcnt(8)
  v_mfma_f32_32x32x16_bf16 v[120:135], v[84:87], a[144:147], v[120:135]
  s_waitcnt vmcnt(9)
  v_cmp_ne_u32 vcc, v3, v35
  s_nop 0
  s_cbranch_vccz L_ok_19
  s_mov_b32 s63, 200000
L_spin_20:
  buffer_load_dword v35, v36, s[40:43], 0 offen sc1
  s_waitcnt vmcnt(0)
  v_cmp_ne_u32 vcc, v3, v35
  s_nop 0
  s_cbranch_vccz L_ok_19
  s_sub_u32 s63, s63, 1
  s_cbranch_scc0 L_spin_20
L_ok_19:
  buffer_load_dwordx4 a[204:207], v2, s[40:43], s71 offen offset:3072 sc1
  ds_read_b64_tr_b16 v[80:81], v28 offset:55296
  ds_read_b64_tr_b16 v[82:83], v28 offset:56320
  s_waitcnt lgkmcnt(8)
  v_mfma_f32_32x32x16_bf16 v[104:119], v[88:91], a[148:151], v[104:119]
  ds_read_b64_tr_b16 v[84:85], v31 offset:55296
  ds_read_b64_tr_b16 v[86:87], v31 offset:56320
  s_waitcnt lgkmcnt(8)
  v_mfma_f32_32x32x16_bf16 v[120:135], v[92:95], a[148:151], v[120:135]
  buffer_load_dwordx4 v7, s[32:35], s59 offen offset:3072 lds
  s_barrier
  ds_read_b64_tr_b16 v[88:89], v29 offset:49152
  ds_read_b64_tr_b16 v[90:91], v29 offset:50176
  s_waitcnt lgkmcnt(8)
  v_mfma_f32_32x32x16_bf16 v[104:119], v[96:99], a[152:155], v[104:119]
  s_add_u32 s71, s52, 102400
  buffer_load_dwordx4 a[208:211], v2, s[40:43], s71 offen offset:0 sc1
  ds_read_b64_tr_b16 v[92:93], v32 offset:49152
  ds_read_b64_tr_b16 v[94:95], v32 offset:50176
  s_waitcnt lgkmcnt(8)
  v_mfma_f32_32x32x16_bf16 v[120:135], v[100:103], a[152:155], v[120:135]
  s_add_u32 s59, s53, 0
  s_add_u32 m0, s51, 131072
  s_nop 0
  buffer_load_dwordx4 v4, s[16:19], s59 offen offset:0 lds
  ds_read_b64_tr_b16 v[96:97], v29 offset:51200
  ds_read_b64_tr_b16 v[98:99], v29 offset:52224
  s_waitcnt lgkmcnt(8)
  v_mfma_f32_32x32x16_bf16 v[104:119], v[80:83], a[156:159], v[104:119]
  ds_read_b64_tr_b16 v[100:101], v32 offset:51200
  ds_read_b64_tr_b16 v[102:103], v32 offset:52224
  s_waitcnt lgkmcnt(8)
  v_mfma_f32_32x32x16_bf16 v[120:135], v[84:87], a[156:159], v[120:135]
  buffer_load_dwordx4 a[212:215], v2, s[40:43], s71 offen offset:1024 sc1
  ds_read_b64_tr_b16 v[80:81], v29 offset:53248
  ds_read_b64_tr_b16 v[82:83], v29 offset:54272
  s_waitcnt lgkmcnt(8)
  v_mfma_f32_32x32x16_bf16 v[104:119], v[88:91], a[160:163], v[104:119]
  buffer_load_dwordx4 v5, s[16:19], s59 offen offset:1024 lds
  ds_read_b64_tr_b16 v[84:85], v32 offset:53248
  ds_read_b64_tr_b16 v[86:87], v32 offset:54272
  s_waitcnt lgkmcnt(8)
  v_mfma_f32_32x32x16_bf16 v[120:135], v[92:95], a[160:163], v[120:135]
  ds_read_b64_tr_b16 v[88:89], v29 offset:55296
  ds_read_b64_tr_b16 v[90:91], v29 offset:56320
  s_waitcnt lgkmcnt(8)
  v_mfma_f32_32x32x16_bf16 v[104:119], v[96:99], a[164:167], v[104:119]
  buffer_load_dwordx4 a[216:219], v2, s[40:43], s71 offen offset:2048 sc1
  ds_read_b64_tr_b16 v[92:93], v32 offset:55296
  ds_read_b64_tr_b16 v[94:95], v32 offset:56320
  s_waitcnt lgkmcnt(8)
  v_mfma_f32_32x32x16_bf16 v[120:135], v[100:103], a[164:167], v[120:135]
  buffer_load_dwordx4 v6, s[16:19], s59 offen offset:2048 lds
  s_barrier
  ds_read_b64_tr_b16 v[96:97], v28 offset:0
  ds_read_b64_tr_b16 v[98:99], v28 offset:1024
  s_waitcnt lgkmcnt(8)
  v_mfma_f32_32x32x16_bf16 v[104:119], v[80:83], a[168:171], v[104:119]
  ds_read_b64_tr_b16 v[100:101], v31 offset:0
  ds_read_b64_tr_b16 v[102:103], v31 offset:1024
  s_waitcnt lgkmcnt(8)
  v_mfma_f32_32x32x16_bf16 v[120:135], v[84:87], a[168:171], v[120:135]
  buffer_load_dwordx4 a[220:223], v2, s[40:43], s71 offen offset:3072 sc1
  ds_read_b64_tr_b16 v[80:81], v28 offset:2048
  ds_read_b64_tr_b16 v[82:83], v28 offset:3072
  s_waitcnt lgkmcnt(8)
  v_mfma_f32_32x32x16_bf16 v[104:119], v[88:91], a[172:175], v[104:119]
  buffer_load_dwordx4 v7, s[16:19], s59 offen offset:3072 lds
  ds_read_b64_tr_b16 v[84:85], v31 offset:2048
  ds_read_b64_tr_b16 v[86:87], v31 offset:3072
  s_waitcnt lgkmcnt(8)
  v_mfma_f32_32x32x16_bf16 v[120:135], v[92:95], a[172:175], v[120:135]
  ds_read_b64_tr_b16 v[88:89], v28 offset:4096
  ds_read_b64_tr_b16 v[90:91], v28 offset:5120
  s_waitcnt lgkmcnt(8)
  v_mfma_f32_32x32x16_bf16 v[104:119], v[96:99], a[176:179], v[104:119]
  s_add_u32 s71, s54, 0
  buffer_load_dwordx4 a[224:227], v2, s[40:43], s71 offen offset:0 sc1
  ds_read_b64_tr_b16 v[92:93], v31 offset:4096
  ds_read_b64_tr_b16 v[94:95], v31 offset:5120
  s_waitcnt lgkmcnt(8)
  v_mfma_f32_32x32x16_bf16 v[120:135], v[100:103], a[176:179], v[120:135]
  s_add_u32 s59, s53, 131072
  s_add_u32 m0, s51, 81920
  s_nop 0
  buffer_load_dwordx4 v4, s[16:19], s59 offen offset:0 lds
  ds_read_b64_tr_b16 v[96:97], v28 offset:6144
  ds_read_b64_tr_b16 v[98:99], v28 offset:7168
  s_waitcnt lgkmcnt(8)
  v_mfma_f32_32x32x16_bf16 v[104:119], v[80:83], a[180:183], v[104:119]
  ds_read_b64_tr_b16 v[100:101], v31 offset:6144
  ds_read_b64_tr_b16 v[102:103], v31 offset:7168
  s_waitcnt lgkmcnt(8)
  v_mfma_f32_32x32x16_bf16 v[120:135], v[84:87], a[180:183], v[120:135]
  buffer_load_dwordx4 a[228:231], v2, s[40:43], s71 offen offset:1024 sc1
  s_waitcnt vmcnt(19)
  s_barrier
  ds_read_b64_tr_b16 v[80:81], v29 offset:0
  ds_read_b64_tr_b16 v[82:83], v29 offset:1024
  s_waitcnt lgkmcnt(8)
  v_mfma_f32_32x32x16_bf16 v[104:119], v[88:91], a[184:187], v[104:119]
  buffer_load_dwordx4 v5, s[16:19], s59 offen offset:1024 lds
  ds_read_b64_tr_b16 v[84:85], v32 offset:0
  ds_read_b64_tr_b16 v[86:87], v32 offset:1024
  s_waitcnt lgkmcnt(8)
  v_mfma_f32_32x32x16_bf16 v[120:135], v[92:95], a[184:187], v[120:135]
  buffer_load_dwordx4 a[232:235], v2, s[40:43], s71 offen offset:2048 sc1
  ds_read_b64_tr_b16 v[88:89], v29 offset:2048
  ds_read_b64_tr_b16 v[90:91], v29 offset:3072
  s_waitcnt lgkmcnt(8)
  v_mfma_f32_32x32x16_bf16 v[104:119], v[96:99], a[188:191], v[104:119]
  ds_read_b64_tr_b16 v[92:93], v32 offset:2048
  ds_read_b64_tr_b16 v[94:95], v32 offset:3072
  s_waitcnt lgkmcnt(8)
  v_mfma_f32_32x32x16_bf16 v[120:135], v[100:103], a[188:191], v[120:135]
  buffer_load_dwordx4 v6, s[16:19], s59 offen offset:2048 lds
  ds_read_b64_tr_b16 v[96:97], v29 offset:4096
  ds_read_b64_tr_b16 v[98:99], v29 offset:5120
  s_waitcnt vmcnt(21) lgkmcnt(8)
  v_mfma_f32_32x32x16_bf16 v[104:119], v[80:83], a[192:195], v[104:119]
  buffer_load_dwordx4 a[236:239], v2, s[40:43], s71 offen offset:3072 sc1
  ds_read_b64_tr_b16 v[100:101], v32 offset:4096
  ds_read_b64_tr_b16 v[102:103], v32 offset:5120
  s_waitcnt lgkmcnt(8)
  v_mfma_f32_32x32x16_bf16 v[120:135], v[84:87], a[192:195], v[120:135]
  ds_read_b64_tr_b16 v[80:81], v29 offset:6144
  ds_read_b64_tr_b16 v[82:83], v29 offset:7168
  s_waitcnt vmcnt(20) lgkmcnt(8)
  v_mfma_f32_32x32x16_bf16 v[104:119], v[88:91], a[196:199], v[104:119]
  buffer_load_dwordx4 v7, s[16:19], s59 offen offset:3072 lds
  ds_read_b64_tr_b16 v[84:85], v32 offset:6144
  ds_read_b64_tr_b16 v[86:87], v32 offset:7168
  s_waitcnt lgkmcnt(8)
  v_mfma_f32_32x32x16_bf16 v[120:135], v[92:95], a[196:199], v[120:135]
  s_add_u32 s71, s54, 8192
  buffer_load_dwordx4 a[240:243], v2, s[40:43], s71 offen offset:0 sc1
  s_waitcnt vmcnt(17)
  s_barrier
  ds_read_b64_tr_b16 v[88:89], v28 offset:16384
  ds_read_b64_tr_b16 v[90:91], v28 offset:17408
  s_waitcnt lgkmcnt(8)
  v_mfma_f32_32x32x16_bf16 v[104:119], v[96:99], a[200:203], v[104:119]
  ds_read_b64_tr_b16 v[92:93], v31 offset:16384
  ds_read_b64_tr_b16 v[94:95], v31 offset:17408
  s_waitcnt lgkmcnt(8)
  v_mfma_f32_32x32x16_bf16 v[120:135], v[100:103], a[200:203], v[120:135]
  s_add_u32 s59, s53, 262144
  s_add_u32 m0, s51, 32768
  s_nop 0
  buffer_load_dwordx4 v4, s[16:19], s59 offen offset:0 lds
  ds_read_b64_tr_b16 v[96:97], v28 offset:18432
  ds_read_b64_tr_b16 v[98:99], v28 offset:19456
  s_waitcnt lgkmcnt(8)
  v_mfma_f32_32x32x16_bf16 v[104:119], v[80:83], a[204:207], v[104:119]
  buffer_load_dwordx4 a[244:247], v2, s[40:43], s71 offen offset:1024 sc1
  ds_read_b64_tr_b16 v[100:101], v31 offset:18432
  ds_read_b64_tr_b16 v[102:103], v31 offset:19456
  s_waitcnt lgkmcnt(8)
  v_mfma_f32_32x32x16_bf16 v[120:135], v[84:87], a[204:207], v[120:135]
  ds_read_b64_tr_b16 v[80:81], v28 offset:20480
  ds_read_b64_tr_b16 v[82:83], v28 offset:21504
  s_waitcnt vmcnt(18) lgkmcnt(8)
  v_mfma_f32_32x32x16_bf16 v[104:119], v[88:91], a[208:211], v[104:119]
  buffer_load_dwordx4 v5, s[16:19], s59 offen offset:1024 lds
  ds_read_b64_tr_b16 v[84:85], v31 offset:20480
  ds_read_b64_tr_b16 v[86:87], v31 offset:21504
  s_waitcnt lgkmcnt(8)
  v_mfma_f32_32x32x16_bf16 v[120:135], v[92:95], a[208:211], v[120:135]
  buffer_load_dwordx4 a[248:251], v2, s[40:43], s71 offen offset:2048 sc1
  ds_read_b64_tr_b16 v[88:89], v28 offset:22528
  ds_read_b64_tr_b16 v[90:91], v28 offset:23552
  s_waitcnt vmcnt(18) lgkmcnt(8)
  v_mfma_f32_32x32x16_bf16 v[104:119], v[96:99], a[212:215], v[104:119]
  buffer_load_dwordx4 v6, s[16:19], s59 offen offset:2048 lds
  ds_read_b64_tr_b16 v[92:93], v31 offset:22528
  ds_read_b64_tr_b16 v[94:95], v31 offset:23552
  s_waitcnt lgkmcnt(8)
  v_mfma_f32_32x32x16_bf16 v[120:135], v[100:103], a[212:215], v[120:135]
  s_waitcnt vmcnt(17) lgkmcnt(6)
  v_mfma_f32_32x32x16_bf16 v[104:119], v[80:83], a[216:219], v[104:119]
  buffer_load_dwordx4 a[252:255], v2, s[40:43], s71 offen offset:3072 sc1
  s_waitcnt lgkmcnt(4)
  v_mfma_f32_32x32x16_bf16 v[120:135], v[84:87], a[216:219], v[120:135]
  buffer_load_dwordx4 v7, s[16:19], s59 offen offset:3072 lds
  s_waitcnt vmcnt(17) lgkmcnt(2)
  v_mfma_f32_32x32x16_bf16 v[104:119], v[88:91], a[220:223], v[104:119]
  s_waitcnt lgkmcnt(0)
  v_mfma_f32_32x32x16_bf16 v[120:135], v[92:95], a[220:223], v[120:135]
  s_add_u32 s71, s54, 16384
  buffer_load_dwordx4 a[0:3], v2, s[40:43], s71 offen offset:0 sc1
  s_waitcnt vmcnt(17)
  s_barrier
  ds_read_b64_tr_b16 v[80:81], v30 offset:0
  ds_read_b64_tr_b16 v[82:83], v30 offset:1024
  ds_read_b64_tr_b16 v[84:85], v33 offset:0
  ds_read_b64_tr_b16 v[86:87], v33 offset:1024
  ds_read_b64_tr_b16 v[88:89], v30 offset:2048
  ds_read_b64_tr_b16 v[90:91], v30 offset:3072
  ds_read_b64_tr_b16 v[92:93], v33 offset:2048
  ds_read_b64_tr_b16 v[94:95], v33 offset:3072
  ds_read_b64_tr_b16 v[96:97], v30 offset:4096
  ds_read_b64_tr_b16 v[98:99], v30 offset:5120
  s_waitcnt vmcnt(16) lgkmcnt(8)
  v_mfma_f32_32x32x16_bf16 v[136:151], v[80:83], a[224:227], 0
  s_add_u32 s59, s53, 393216
  s_add_u32 m0, s51, 49152
  s_nop 0
  buffer_load_dwordx4 v4, s[16:19], s59 offen offset:0 lds
  ds_read_b64_tr_b16 v[100:101], v33 offset:4096
  ds_read_b64_tr_b16 v[102:103], v33 offset:5120
  s_waitcnt lgkmcnt(8)
  v_mfma_f32_32x32x16_bf16 v[152:167], v[84:87], a[224:227], 0
  ds_read_b64_tr_b16 v[80:81], v30 offset:6144
  ds_read_b64_tr_b16 v[82:83], v30 offset:7168
  s_waitcnt vmcnt(15) lgkmcnt(8)
  v_mfma_f32_32x32x16_bf16 v[136:151], v[88:91], a[228:231], v[136:151]
  buffer_load_dwordx4 a[4:7], v2, s[40:43], s71 offen offset:1024 sc1
  v_add_u32 v200, s51, v2
  v_add_u32 v200, 98304, v200
  v_xor_b32 v201, 4096, v200
  ds_write_b128 v200, v[120:123] offset:0
  ds_write_b128 v200, v[124:127] offset:1024
  ds_write_b128 v200, v[128:131] offset:2048
  ds_write_b128 v200, v[132:135] offset:3072
  ds_read_b64_tr_b16 v[84:85], v33 offset:6144
  ds_read_b64_tr_b16 v[86:87], v33 offset:7168
  s_waitcnt lgkmcnt(12)
  v_mfma_f32_32x32x16_bf16 v[152:167], v[92:95], a[228:231], v[152:167]
  buffer_load_dwordx4 v5, s[16:19], s59 offen offset:1024 lds
  s_waitcnt vmcnt(12)
  s_barrier
  ds_read_b64_tr_b16 v[88:89], v29 offset:16384
  ds_read_b64_tr_b16 v[90:91], v29 offset:17408
  s_waitcnt lgkmcnt(12)
  v_mfma_f32_32x32x16_bf16 v[136:151], v[96:99], a[232:235], v[136:151]
  ds_read_b64_tr_b16 v[92:93], v32 offset:16384
  ds_read_b64_tr_b16 v[94:95], v32 offset:17408
  s_waitcnt lgkmcnt(12)
  v_mfma_f32_32x32x16_bf16 v[152:167], v[100:103], a[232:235], v[152:167]
  buffer_load_dwordx4 a[8:11], v2, s[40:43], s71 offen offset:2048 sc1
  ds_read_b64_tr_b16 v[96:97], v29 offset:18432
  ds_read_b64_tr_b16 v[98:99], v29 offset:19456
  s_waitcnt lgkmcnt(12)
  v_mfma_f32_32x32x16_bf16 v[136:151], v[80:83], a[236:239], v[136:151]
  buffer_load_dwordx4 v6, s[16:19], s59 offen offset:2048 lds
  ds_read_b64_tr_b16 v[100:101], v32 offset:18432
  ds_read_b64_tr_b16 v[102:103], v32 offset:19456
  s_waitcnt lgkmcnt(8)
  v_mfma_f32_32x32x16_bf16 v[152:167], v[84:87], a[236:239], v[152:167]
  ds_read_b64_tr_b16 v[80:81], v29 offset:20480
  ds_read_b64_tr_b16 v[82:83], v29 offset:21504
  s_waitcnt vmcnt(13) lgkmcnt(8)
  v_mfma_f32_32x32x16_bf16 v[136:151], v[88:91], a[240:243], v[136:151]
  buffer_load_dwordx4 a[12:15], v2, s[40:43], s71 offen offset:3072 sc1
  ds_read_b64_tr_b16 v[84:85], v32 offset:20480
  ds_read_b64_tr_b16 v[86:87], v32 offset:21504
  s_waitcnt lgkmcnt(8)
  v_mfma_f32_32x32x16_bf16 v[152:167], v[92:95], a[240:243], v[152:167]
  buffer_load_dwordx4 v7, s[16:19], s59 offen offset:3072 lds
  ds_read_b64_tr_b16 v[88:89], v29 offset:22528
  ds_read_b64_tr_b16 v[90:91], v29 offset:23552
  s_waitcnt vmcnt(13) lgkmcnt(8)
  v_mfma_f32_32x32x16_bf16 v[136:151], v[96:99], a[244:247], v[136:151]
  s_add_u32 s71, s54, 24576
  buffer_load_dwordx4 a[16:19], v2, s[40:43], s71 offen offset:0 sc1
  ds_read_b64_tr_b16 v[92:93], v32 offset:22528
  ds_read_b64_tr_b16 v[94:95], v32 offset:23552
  s_waitcnt lgkmcnt(8)
  v_mfma_f32_32x32x16_bf16 v[152:167], v[100:103], a[244:247], v[152:167]
  s_waitcnt vmcnt(9)
  s_barrier
  ds_read_b64_tr_b16 v[96:97], v28 offset:32768
  ds_read_b64_tr_b16 v[98:99], v28 offset:33792
  s_waitcnt lgkmcnt(8)
  v_mfma_f32_32x32x16_bf16 v[136:151], v[80:83], a[248:251], v[136:151]
  buffer_load_dwordx4 a[20:23], v2, s[40:43], s71 offen offset:1024 sc1
  ds_read_b128 v[120:123], v201 offset:0
  ds_read_b128 v[124:127], v201 offset:1024
  ds_read_b128 v[128:131], v201 offset:2048
  ds_read_b128 v[132:135], v201 offset:3072
  ds_read_b64_tr_b16 v[100:101], v31 offset:32768
  ds_read_b64_tr_b16 v[102:103], v31 offset:33792
  s_waitcnt lgkmcnt(12)
  v_mfma_f32_32x32x16_bf16 v[152:167], v[84:87], a[248:251], v[152:167]
  buffer_load_dwordx4 a[24:27], v2, s[40:43], s71 offen offset:2048 sc1
  ds_read_b64_tr_b16 v[80:81], v28 offset:34816
  ds_read_b64_tr_b16 v[82:83], v28 offset:35840
  s_waitcnt lgkmcnt(12)
  v_mfma_f32_32x32x16_bf16 v[136:151], v[88:91], a[252:255], v[136:151]
  ds_read_b64_tr_b16 v[84:85], v31 offset:34816
  ds_read_b64_tr_b16 v[86:87], v31 offset:35840
  s_waitcnt lgkmcnt(12)
  v_mfma_f32_32x32x16_bf16 v[152:167], v[92:95], a[252:255], v[152:167]
  buffer_load_dwordx4 a[28:31], v2, s[40:43], s71 offen offset:3072 sc1
  ds_read_b64_tr_b16 v[88:89], v28 offset:36864
  ds_read_b64_tr_b16 v[90:91], v28 offset:37888
  s_waitcnt vmcnt(11) lgkmcnt(12)
  v_mfma_f32_32x32x16_bf16 v[136:151], v[96:99], a[0:3], v[136:151]
  ds_read_b64_tr_b16 v[92:93], v31 offset:36864
  ds_read_b64_tr_b16 v[94:95], v31 offset:37888
  s_waitcnt lgkmcnt(8)
  v_mfma_f32_32x32x16_bf16 v[152:167], v[100:103], a[0:3], v[152:167]
  ds_read_b64_tr_b16 v[96:97], v28 offset:38912
  ds_read_b64_tr_b16 v[98:99], v28 offset:39936
  s_waitcnt vmcnt(9) lgkmcnt(8)
  v_mfma_f32_32x32x16_bf16 v[136:151], v[80:83], a[4:7], v[136:151]
  ds_read_b64_tr_b16 v[100:101], v31 offset:38912
  ds_read_b64_tr_b16 v[102:103], v31 offset:39936
  s_waitcnt lgkmcnt(8)
  v_mfma_f32_32x32x16_bf16 v[152:167], v[84:87], a[4:7], v[152:167]
  s_waitcnt vmcnt(4)
  s_barrier
  ds_read_b64_tr_b16 v[80:81], v28 offset:49152
  ds_read_b64_tr_b16 v[82:83], v28 offset:50176
  s_waitcnt lgkmcnt(8)
  v_mfma_f32_32x32x16_bf16 v[136:151], v[88:91], a[8:11], v[136:151]
  ds_read_b64_tr_b16 v[84:85], v31 offset:49152
  ds_read_b64_tr_b16 v[86:87], v31 offset:50176
  s_waitcnt lgkmcnt(8)
  v_mfma_f32_32x32x16_bf16 v[152:167], v[92:95], a[8:11], v[152:167]
  ds_read_b64_tr_b16 v[88:89], v28 offset:51200
  ds_read_b64_tr_b16 v[90:91], v28 offset:52224
  s_waitcnt lgkmcnt(8)
  v_mfma_f32_32x32x16_bf16 v[136:151], v[96:99], a[12:15], v[136:151]
  ds_read_b64_tr_b16 v[92:93], v31 offset:51200
  ds_read_b64_tr_b16 v[94:95], v31 offset:52224
  s_waitcnt lgkmcnt(8)
  v_mfma_f32_32x32x16_bf16 v[152:167], v[100:103], a[12:15], v[152:167]
  ds_read_b64_tr_b16 v[96:97], v28 offset:53248
  ds_read_b64_tr_b16 v[98:99], v28 offset:54272
  s_waitcnt vmcnt(3) lgkmcnt(8)
  v_mfma_f32_32x32x16_bf16 v[136:151], v[80:83], a[16:19], v[136:151]
  ds_read_b64_tr_b16 v[100:101], v31 offset:53248
  ds_read_b64_tr_b16 v[102:103], v31 offset:54272
  s_waitcnt lgkmcnt(8)
  v_mfma_f32_32x32x16_bf16 v[152:167], v[84:87], a[16:19], v[152:167]
  ds_read_b64_tr_b16 v[80:81], v28 offset:55296
  ds_read_b64_tr_b16 v[82:83], v28 offset:56320
  s_waitcnt vmcnt(2) lgkmcnt(8)
  v_mfma_f32_32x32x16_bf16 v[136:151], v[88:91], a[20:23], v[136:151]
  ds_read_b64_tr_b16 v[84:85], v31 offset:55296
  ds_read_b64_tr_b16 v[86:87], v31 offset:56320
  s_waitcnt lgkmcnt(8)
  v_mfma_f32_32x32x16_bf16 v[152:167], v[92:95], a[20:23], v[152:167]
  s_waitcnt vmcnt(1) lgkmcnt(6)
  v_mfma_f32_32x32x16_bf16 v[136:151], v[96:99], a[24:27], v[136:151]
  s_waitcnt lgkmcnt(4)
  v_mfma_f32_32x32x16_bf16 v[152:167], v[100:103], a[24:27], v[152:167]
  s_waitcnt vmcnt(0) lgkmcnt(2)
  v_mfma_f32_32x32x16_bf16 v[136:151], v[80:83], a[28:31], v[136:151]
  s_waitcnt lgkmcnt(0)
  v_mfma_f32_32x32x16_bf16 v[152:167], v[84:87], a[28:31], v[152:167]
  v_lshlrev_b32 v204, 16, v60
  v_and_b32 v205, 0xffff0000, v60
  v_add_f32 v104, v104, v120
  v_add_f32 v105, v105, v121
  v_add_f32 v104, v104, v204
  v_add_f32 v105, v105, v205
  v_lshlrev_b32 v206, 16, v61
  v_and_b32 v207, 0xffff0000, v61
  v_add_f32 v106, v106, v122
  v_add_f32 v107, v107, v123
  v_add_f32 v106, v106, v206
  v_add_f32 v107, v107, v207
  v_add_u32 v202, s51, v2
  v_add_u32 v202, 114688, v202
  v_xor_b32 v203, 4096, v202
  ds_write_b128 v202, v[152:155] offset:0
  ds_write_b128 v202, v[156:159] offset:1024
  ds_write_b128 v202, v[160:163] offset:2048
  ds_write_b128 v202, v[164:167] offset:3072
  v_lshlrev_b32 v208, 16, v62
  v_and_b32 v209, 0xffff0000, v62
  v_add_f32 v108, v108, v124
  v_add_f32 v109, v109, v125
  v_add_f32 v108, v108, v208
  v_add_f32 v109, v109, v209
  v_lshlrev_b32 v210, 16, v63
  v_and_b32 v211, 0xffff0000, v63
  v_add_f32 v110, v110, v126
  v_add_f32 v111, v111, v127
  v_add_f32 v110, v110, v210
  v_add_f32 v111, v111, v211
  v_lshlrev_b32 v204, 16, v64
  v_and_b32 v205, 0xffff0000, v64
  v_add_f32 v112, v112, v128
  v_add_f32 v113, v113, v129
  v_add_f32 v112, v112, v204
  v_add_f32 v113, v113, v205
  v_lshlrev_b32 v206, 16, v65
  v_and_b32 v207, 0xffff0000, v65
  v_add_f32 v114, v114, v130
  v_add_f32 v115, v115, v131
  v_add_f32 v114, v114, v206
  v_add_f32 v115, v115, v207
  v_lshlrev_b32 v208, 16, v66
  v_and_b32 v209, 0xffff0000, v66
  v_add_f32 v116, v116, v132
  v_add_f32 v117, v117, v133
  v_add_f32 v116, v116, v208
  v_add_f32 v117, v117, v209
  v_lshlrev_b32 v210, 16, v67
  v_and_b32 v211, 0xffff0000, v67
  v_add_f32 v118, v118, v134
  v_add_f32 v119, v119, v135
  v_add_f32 v118, v118, v210
  v_add_f32 v119, v119, v211
  s_waitcnt lgkmcnt(0)
  s_barrier
  ds_read_b128 v[152:155], v203 offset:0
  ds_read_b128 v[156:159], v203 offset:1024
  ds_read_b128 v[160:163], v203 offset:2048
  ds_read_b128 v[164:167], v203 offset:3072
  v_pk_mul_f32 v[216:217], v[104:105], s[68:69] neg_lo:[1,0] neg_hi:[1,0]
  v_pk_mul_f32 v[218:219], v[106:107], s[68:69] neg_lo:[1,0] neg_hi:[1,0]
  v_pk_mul_f32 v[220:221], v[108:109], s[68:69] neg_lo:[1,0] neg_hi:[1,0]
  v_pk_mul_f32 v[222:223], v[110:111], s[68:69] neg_lo:[1,0] neg_hi:[1,0]
  v_pk_mul_f32 v[224:225], v[112:113], s[68:69] neg_lo:[1,0] neg_hi:[1,0]
  v_pk_mul_f32 v[226:227], v[114:115], s[68:69] neg_lo:[1,0] neg_hi:[1,0]
  v_pk_mul_f32 v[228:229], v[116:117], s[68:69] neg_lo:[1,0] neg_hi:[1,0]
  v_pk_mul_f32 v[230:231], v[118:119], s[68:69] neg_lo:[1,0] neg_hi:[1,0]
  v_exp_f32 v216, v216
  v_exp_f32 v217, v217
  v_exp_f32 v218, v218
  v_exp_f32 v219, v219
  v_exp_f32 v220, v220
  v_exp_f32 v221, v221
  v_exp_f32 v222, v222
  v_exp_f32 v223, v223
  v_exp_f32 v224, v224
  v_exp_f32 v225, v225
  v_exp_f32 v226, v226
  v_exp_f32 v227, v227
  v_exp_f32 v228, v228
  v_exp_f32 v229, v229
  v_exp_f32 v230, v230
  v_exp_f32 v231, v231
  v_add_f32 v216, 1.0, v216
  v_add_f32 v217, 1.0, v217
  v_add_f32 v218, 1.0, v218
  v_add_f32 v219, 1.0, v219
  v_add_f32 v220, 1.0, v220
  v_add_f32 v221, 1.0, v221
  v_add_f32 v222, 1.0, v222
  v_add_f32 v223, 1.0, v223
  v_add_f32 v224, 1.0, v224
  v_add_f32 v225, 1.0, v225
  v_add_f32 v226, 1.0, v226
  v_add_f32 v227, 1.0, v227
  v_add_f32 v228, 1.0, v228
  v_add_f32 v229, 1.0, v229
  v_add_f32 v230, 1.0, v230
  v_add_f32 v231, 1.0, v231
  v_rcp_f32 v216, v216
  v_rcp_f32 v217, v217
  v_rcp_f32 v218, v218
  v_rcp_f32 v219, v219
  v_rcp_f32 v220, v220
  v_rcp_f32 v221, v221
  v_rcp_f32 v222, v222
  v_rcp_f32 v223, v223
  v_rcp_f32 v224, v224
  v_rcp_f32 v225, v225
  v_rcp_f32 v226, v226
  v_rcp_f32 v227, v227
  v_rcp_f32 v228, v228
  v_rcp_f32 v229, v229
  v_rcp_f32 v230, v230
  v_rcp_f32 v231, v231
  s_waitcnt lgkmcnt(3)
  v_pk_add_f32 v[136:137], v[136:137], v[152:153]
  v_pk_mul_f32 v[216:217], v[216:217], v[104:105]
  v_pk_add_f32 v[138:139], v[138:139], v[154:155]
  v_pk_mul_f32 v[218:219], v[218:219], v[106:107]
  s_waitcnt lgkmcnt(2)
  v_pk_add_f32 v[140:141], v[140:141], v[156:157]
  v_pk_mul_f32 v[220:221], v[220:221], v[108:109]
  v_pk_add_f32 v[142:143], v[142:143], v[158:159]
  v_pk_mul_f32 v[222:223], v[222:223], v[110:111]
  s_waitcnt lgkmcnt(1)
  v_pk_add_f32 v[144:145], v[144:145], v[160:161]
  v_pk_mul_f32 v[224:225], v[224:225], v[112:113]
  v_pk_add_f32 v[146:147], v[146:147], v[162:163]
  v_pk_mul_f32 v[226:227], v[226:227], v[114:115]
  s_waitcnt lgkmcnt(0)
  v_pk_add_f32 v[148:149], v[148:149], v[164:165]
  v_pk_mul_f32 v[228:229], v[228:229], v[116:117]
  v_pk_add_f32 v[150:151], v[150:151], v[166:167]
  v_pk_mul_f32 v[230:231], v[230:231], v[118:119]
  v_lshlrev_b32 v204, 16, v52
  v_and_b32 v205, 0xffff0000, v52
  v_pk_fma_f32 v[216:217], v[216:217], v[136:137], v[204:205]
  v_cvt_pk_bf16_f32 v232, v216, v217
  v_lshlrev_b32 v206, 16, v53
  v_and_b32 v207, 0xffff0000, v53
  v_pk_fma_f32 v[218:219], v[218:219], v[138:139], v[206:207]
  v_cvt_pk_bf16_f32 v233, v218, v219
  buffer_store_dwordx2 v[232:233], v37, s[36:39], 0 offen offset:0
  v_lshlrev_b32 v208, 16, v54
  v_and_b32 v209, 0xffff0000, v54
  v_pk_fma_f32 v[220:221], v[220:221], v[140:141], v[208:209]
  v_cvt_pk_bf16_f32 v234, v220, v221
  v_lshlrev_b32 v210, 16, v55
  v_and_b32 v211, 0xffff0000, v55
  v_pk_fma_f32 v[222:223], v[222:223], v[142:143], v[210:211]
  v_cvt_pk_bf16_f32 v235, v222, v223
  buffer_store_dwordx2 v[234:235], v37, s[36:39], 0 offen offset:16
  v_lshlrev_b32 v204, 16, v56
  v_and_b32 v205, 0xffff0000, v56
  v_pk_fma_f32 v[224:225], v[224:225], v[144:145], v[204:205]
  v_cvt_pk_bf16_f32 v236, v224, v225
  v_lshlrev_b32 v206, 16, v57
  v_and_b32 v207, 0xffff0000, v57
  v_pk_fma_f32 v[226:227], v[226:227], v[146:147], v[206:207]
  v_cvt_pk_bf16_f32 v237, v226, v227
  buffer_store_dwordx2 v[236:237], v37, s[36:39], 0 offen offset:32
  v_lshlrev_b32 v208, 16, v58
  v_and_b32 v209, 0xffff0000, v58
  v_pk_fma_f32 v[228:229], v[228:229], v[148:149], v[208:209]
  v_cvt_pk_bf16_f32 v238, v228, v229
  v_lshlrev_b32 v210, 16, v59
  v_and_b32 v211, 0xffff0000, v59
  v_pk_fma_f32 v[230:231], v[230:231], v[150:151], v[210:211]
  v_cvt_pk_bf16_f32 v239, v230, v231
  buffer_store_dwordx2 v[238:239], v37, s[36:39], 0 offen offset:48
  s_cmp_eq_u32 s57, 0
  s_cbranch_scc0 L_noep_21
  s_mov_b32 s60, 18202624
  buffer_store_dword v3, v34, s[40:43], s60 offen sc1
L_noep_21:
L_end:
  s_endpgm
.section .rodata,"a"
.p2align 6
.amdhsa_kernel recurrent_scan__linear_kernel_hedgehog__mixer_s_mlp__prompt_kernel
  .amdhsa_next_free_vgpr 512
  .amdhsa_next_free_sgpr 102
  .amdhsa_accum_offset 256
  .amdhsa_group_segment_fixed_size 0
  .amdhsa_kernarg_size 96
  .amdhsa_user_sgpr_count 2
  .amdhsa_user_sgpr_kernarg_segment_ptr 1
  .amdhsa_system_sgpr_workgroup_id_x 1
  .amdhsa_float_denorm_mode_32 3
  .amdhsa_float_denorm_mode_16_64 3
.end_amdhsa_kernel
```
